```python
import torch

def _softmax(x, axis=-1):
    return torch.softmax(x, dim=axis)
def _gelu(x):
    return torch.nn.functional.gelu(x, approximate="tanh")
def _silu(x):
    return torch.nn.functional.silu(x)
def _sigmoid(x):
    return torch.sigmoid(x)
def _layernorm(x, axis=-1, eps=1e-5):
    m = x.mean(dim=axis, keepdim=True)
    v = x.var(dim=axis, keepdim=True, unbiased=False)
    return (x - m) / torch.sqrt(v + eps)
def _scatter_add(tgt, idx, src, axis=0):
    return tgt.clone().index_add_(axis, idx, src)
def _segment_sum(src, seg, n):
    out = torch.zeros((n,) + src.shape[1:], dtype=src.dtype)
    return out.index_add_(0, seg, src)
def _pad(x, pw):
    flat = tuple(v for pair in reversed(pw) for v in pair)
    return torch.nn.functional.pad(x, flat)

kernel_name = 'interleave_layers__sliding_block_cached__glu_gated_swiglu__decode'

def setup_inputs():

    _w = (lambda a: (lambda t: t.to(torch.bfloat16) if t.is_floating_point() else t)(torch.as_tensor(a)))
    def _A_setup():
        B, Sq, D = 1, 1, 512
        Hq, Hkv, Sk, Dh = 32, 32, 4096, 128
        assert Hq % Hkv == 0, (Hq, Hkv)
        return {
            "x": _w((lambda *s: torch.randn(*s, dtype=torch.bfloat16) * 0.05)(B, Sq, D)),
            "k_cache": _w((lambda *s: torch.randn(*s, dtype=torch.bfloat16) * 0.8)(B, Hkv, Sk, Dh)),
            "v_cache": _w((lambda *s: torch.randn(*s, dtype=torch.bfloat16) * 0.8)(B, Hkv, Sk, Dh)),
            "wq": _w((lambda *s: torch.randn(*s, dtype=torch.bfloat16) * 0.8)(D, Hq * Dh) * (D ** -0.5)),
            "wo": _w((lambda *s: torch.randn(*s, dtype=torch.bfloat16) * 0.8)(Hq * Dh, D) * ((Hq * Dh) ** -0.5)),
        }
    _A_in = _A_setup()

    def _B_setup():
        B, S, D, F = 1, 1, 512, 1376
        return {
            "x": _w((lambda *s: torch.randn(*s, dtype=torch.bfloat16) * 0.05)(B, S, D)),
            "w1": _w((lambda *s: torch.randn(*s, dtype=torch.bfloat16) * 0.2)(D, F) * (2.0 / D) ** 0.5),
            "w3": _w((lambda *s: torch.randn(*s, dtype=torch.bfloat16) * 0.2)(D, F) * (2.0 / D) ** 0.5),
            "w2": _w((lambda *s: torch.randn(*s, dtype=torch.bfloat16) * 0.2)(F, D) * (2.0 / F) ** 0.5),
        }
    _B_in = _B_setup()

    return {
        "A_x": _A_in["x"],
        "A_k_cache": _A_in["k_cache"],
        "A_v_cache": _A_in["v_cache"],
        "A_wq": _A_in["wq"],
        "A_wo": _A_in["wo"],
        "B_x": _B_in["x"],
        "B_w1": _B_in["w1"],
        "B_w3": _B_in["w3"],
        "B_w2": _B_in["w2"],
    }

def reference(A_x, A_k_cache, A_v_cache, A_wq, A_wo, B_x, B_w1, B_w3, B_w2):
    def _A_ref(x, k_cache, v_cache, wq, wo):
        B, Sq, D = x.shape
        Hq, Dh = 32, 128
        Hkv, Sk = k_cache.shape[1], k_cache.shape[2]
        W = min(4096, max(256, Sk // 4))
        rep = Hq // Hkv
        q = (lambda x, *d: x.permute(*d))((x @ wq).reshape(B, Sq, Hq, Dh), 0, 2, 1, 3)
        k = (lambda x, n, axis: torch.repeat_interleave(x, n, dim=axis))(k_cache[:, :, Sk - W:, :], rep, axis=1)
        v = (lambda x, n, axis: torch.repeat_interleave(x, n, dim=axis))(v_cache[:, :, Sk - W:, :], rep, axis=1)
        scores = torch.einsum("bhqd,bhkd->bhqk", q, k) * (Dh ** -0.5)
        p = _softmax(scores, axis=-1)
        o = torch.einsum("bhqk,bhkd->bhqd", p, v)
        return (lambda x, *d: x.permute(*d))(o, 0, 2, 1, 3).reshape(B, Sq, Hq * Dh) @ wo

    def _B_ref(x, w1, w3, w2):
        gate = torch.einsum("bsd,df->bsf", x, w1)
        up = torch.einsum("bsd,df->bsf", x, w3)
        h = _silu(gate) * up
        out = torch.einsum("bsf,fd->bsd", h, w2)
        return out

    x = A_x
    x = x + _A_ref(_layernorm(x, axis=-1), A_k_cache, A_v_cache, A_wq, A_wo)
    x = x + _B_ref(_layernorm(x, axis=-1), B_w1, B_w3, B_w2)
    x = x + _A_ref(_layernorm(x, axis=-1), A_k_cache, A_v_cache, A_wq, A_wo)
    x = x + _B_ref(_layernorm(x, axis=-1), B_w1, B_w3, B_w2)
    return x
```

```asm
; @launch grid=(256,1,1) block=(320,1,1) lds=131072
.amdgcn_target "amdgcn-amd-amdhsa--gfx950"
.text
.globl interleave_layers__sliding_block_cached__glu_gated_swiglu__decode_kernel
.p2align 8
.type interleave_layers__sliding_block_cached__glu_gated_swiglu__decode_kernel,@function
interleave_layers__sliding_block_cached__glu_gated_swiglu__decode_kernel:
    s_cmp_ge_u32 s2, 256
    s_cbranch_scc1 L_end
    s_load_dwordx16 s[4:19], s[0:1], 0
    s_load_dwordx8 s[20:27], s[0:1], 64
    v_lshrrev_b32 v236, 6, v0
    s_lshr_b32 s69, s2, 3
    v_readfirstlane_b32 s72, v236
    s_getpc_b64 s[96:97]
L_pc:
    s_lshl_b32 s3, s69, 2
    s_add_u32 s3, s3, s72
    s_lshl_b32 s3, s3, 7
    s_min_u32 s3, s3, L_code_end-L_pc-128
    s_load_dword s95, s[96:97], s3
    s_add_u32 s3, s3, 64
    s_load_dword s95, s[96:97], s3
    v_and_b32 v1, 63, v0
    s_and_b32 s68, s2, 7
    s_and_b32 s70, s69, 7
    s_lshr_b32 s71, s69, 3
    s_lshl_b32 s66, s68, 2
    s_add_u32 s66, s66, s71
    v_lshlrev_b32 v2, 4, v1
    v_and_b32 v240, 15, v1
    v_lshrrev_b32 v241, 4, v1
    v_bfe_u32 v242, v1, 2, 2
    v_and_b32 v243, 3, v1
    s_lshl_b32 s78, s72, 15
    v_lshlrev_b32 v236, 2, v241
    v_xor_b32 v236, v236, v240
    v_lshlrev_b32 v236, 4, v236
    v_lshl_add_u32 v236, v241, 13, v236
    v_add_u32 v245, s78, v236
    s_lshl_b32 s79, s72, 10
    v_lshl_add_u32 v236, v241, 2, v243
    v_lshlrev_b32 v236, 4, v236
    v_and_b32 v237, 1, v242
    v_lshl_add_u32 v236, v237, 9, v236
    v_lshrrev_b32 v237, 1, v242
    v_lshl_add_u32 v236, v237, 15, v236
    s_lshl_b32 s80, s72, 13
    v_add_u32 v246, s80, v236
    v_add_u32 v235, s80, v2
    s_add_u32 m0, s79, 12288
    s_lshl_b32 s78, s70, 19
    s_lshl_b32 s80, s66, 8
    s_add_u32 s78, s78, s80
    s_lshl_b32 s80, s66, 20
    s_lshl_b32 s77, s70, 10
    s_add_u32 s80, s80, s77
    s_add_u32 s80, s80, 0xc0000
    s_mov_b32 s58, 0x7e100
    s_mov_b32 s59, 0x20000
    s_mov_b32 s46, 0x400
    s_mov_b32 s47, 0x20000
    s_mov_b32 s30, 0x3e400
    s_mov_b32 s31, 0x20000
    s_mov_b32 s34, 0x3e400
    s_mov_b32 s35, 0x20000
    s_mov_b32 s38, 0x14c000
    s_mov_b32 s39, 0x20000
    s_mov_b32 s42, 0x400
    s_mov_b32 s43, 0x20000
    s_add_u32 s93, s71, s68
    s_and_b32 s93, s93, 3
    s_lshl_b32 s93, s93, 16
    s_lshl_b32 s83, s68, 16
    s_add_u32 s83, s83, 0x29000
    v_mov_b32 v220, 0
    v_mov_b32 v224, 0x3f803f80
    v_mov_b32 v212, -1
    v_mov_b32 v221, 0
    v_mov_b32 v225, 0x3f803f80
    v_mov_b32 v213, -1
    v_mov_b32 v222, 0
    v_mov_b32 v226, 0x3f803f80
    v_mov_b32 v214, -1
    v_mov_b32 v223, 0
    v_mov_b32 v227, 0x3f803f80
    v_mov_b32 v215, -1
    s_waitcnt lgkmcnt(0)
    s_cmp_eq_u32 s72, 4
    s_cbranch_scc1 L_helper
    s_mov_b32 s44, s4
    s_and_b32 s45, s5, 0xffff
    buffer_load_dwordx4 v[216:219], v2, s[44:47], 0 offen
    s_add_u32 s56, s10, s78
    s_addc_u32 s57, s11, 0
    s_and_b32 s57, s57, 0xffff
    s_mov_b32 s78, 0
    buffer_load_dwordx4 v245, s[56:59], s78 offen nt lds
    s_add_u32 s78, s78, 0x20000
    s_add_u32 m0, m0, 4096
    s_nop 0
    buffer_load_dwordx4 v245, s[56:59], s78 offen nt lds
    s_add_u32 s78, s78, 0x20000
    s_add_u32 m0, m0, 4096
    s_nop 0
    buffer_load_dwordx4 v245, s[56:59], s78 offen nt lds
    s_add_u32 s78, s78, 0x20000
    s_add_u32 m0, m0, 4096
    s_nop 0
    buffer_load_dwordx4 v245, s[56:59], s78 offen nt lds
    s_add_u32 s28, s6, s80
    s_addc_u32 s29, s7, 0
    s_and_b32 s29, s29, 0xffff
    buffer_load_dwordx4 v[36:39], v246, s[28:31], s93 offen offset:0 nt
    buffer_load_dwordx4 v[40:43], v246, s[28:31], s93 offen offset:256 nt
    s_add_u32 s93, s93, 65536
    s_and_b32 s93, s93, 0x3ffff
    s_mov_b32 s36, s26
    s_and_b32 s37, s27, 0xffff
    buffer_load_dword v191, off, s[36:39], 0 offset:0 sc1
    s_add_u32 s32, s8, s80
    s_addc_u32 s33, s9, 0
    s_and_b32 s33, s33, 0xffff
    s_mov_b32 s40, s22
    s_and_b32 s41, s23, 0xffff
    s_cmp_lg_u32 s72, 0
    s_cbranch_scc1 L_z_done
    ds_write_b128 v2, v[220:223] offset:0
    ds_write_b128 v2, v[220:223] offset:1024
    v_and_b32 v236, 0xf0, v2
    ds_write_b128 v236, v[220:223] offset:2048
    v_and_b32 v236, 7, v1
    v_lshlrev_b32 v236, 8, v236
    ds_write_b128 v236, v[224:227] offset:48
L_z_done:
    s_mov_b32 s60, s69
    s_lshr_b32 s78, s60, 1
    s_bitcmp1_b32 s60, 0
    s_cbranch_scc1 L_role_odd
    s_mov_b32 s81, 1
    s_mov_b32 s82, s78
    s_lshr_b32 s79, s78, 3
    s_lshl_b32 s80, s68, 1
    s_add_u32 s79, s79, s80
    s_lshl_b32 s79, s79, 18
    s_and_b32 s80, s78, 7
    s_lshl_b32 s80, s80, 7
    s_add_u32 s79, s79, s80
    s_add_u32 s48, s12, s79
    s_addc_u32 s49, s13, 0
    s_and_b32 s49, s49, 0xffff
    s_mov_b32 s50, 0x3fc80
    s_mov_b32 s51, 0x20000
    s_mov_b32 s52, s12
    s_and_b32 s53, s13, 0xffff
    s_mov_b32 s54, 0x0
    s_mov_b32 s55, 0x20000
    s_mov_b32 s56, s12
    s_and_b32 s57, s13, 0xffff
    s_mov_b32 s58, 0x0
    s_mov_b32 s59, 0x20000
    s_branch L_role_done
L_role_odd:
    s_mul_i32 s79, s68, 5
    s_min_u32 s80, s68, 3
    s_add_u32 s79, s79, s80
    s_cmp_lt_u32 s68, 3
    s_cselect_b32 s80, 6, 5
    s_cmp_ge_u32 s78, 8
    s_cselect_b32 s81, 3, 0
    s_cmp_lt_u32 s78, s80
    s_cselect_b32 s81, 2, s81
    s_cselect_b32 s77, s78, 0
    s_add_u32 s82, s79, s77
    s_min_u32 s82, s82, 42
    s_lshl_b32 s79, s82, 6
    s_sub_u32 s78, 0x158000, s79
    s_add_u32 s48, s16, s79
    s_addc_u32 s49, s17, 0
    s_and_b32 s49, s49, 0xffff
    s_mov_b32 s50, 0x0
    s_mov_b32 s51, 0x20000
    s_add_u32 s52, s18, s79
    s_addc_u32 s53, s19, 0
    s_and_b32 s53, s53, 0xffff
    s_mov_b32 s54, 0x0
    s_mov_b32 s55, 0x20000
    s_mov_b32 s50, s78
    s_mov_b32 s54, s78
    s_lshl_b32 s79, s82, 15
    s_sub_u32 s78, 0x158000, s79
    s_add_u32 s56, s20, s79
    s_addc_u32 s57, s21, 0
    s_and_b32 s57, s57, 0xffff
    s_mov_b32 s58, 0x0
    s_mov_b32 s59, 0x20000
    s_mov_b32 s58, s78
L_role_done:
    s_mov_b32 s7, 0x3f803f80
    v_mov_b32 v237, 0
    v_cmp_eq_u32 vcc, 0, v1
    v_mov_b32 v247, 0x80000000
    s_nop 0
    v_cndmask_b32 v13, v247, v237, vcc
    s_lshl_b32 s78, s72, 7
    v_lshlrev_b32 v237, 5, v241
    v_and_b32 v239, 1, v1
    v_lshl_add_u32 v237, v239, 4, v237
    v_add_u32 v237, s78, v237
    v_cmp_gt_u32 vcc, 2, v240
    v_mov_b32 v247, 0x80000000
    s_nop 0
    v_cndmask_b32 v5, v247, v237, vcc
    v_lshrrev_b32 v239, 1, v240
    v_cmp_eq_u32 vcc, 1, v239
    v_mov_b32 v247, 0x80000000
    s_nop 0
    v_cndmask_b32 v202, v247, v237, vcc
    v_lshl_add_u32 v203, v241, 3, v242
    v_xor_b32 v239, s72, v242
    v_lshl_add_u32 v239, v239, 2, v243
    v_lshlrev_b32 v239, 4, v239
    v_lshl_add_u32 v233, v203, 8, v239
    v_and_b32 v236, 7, v1
    v_lshlrev_b32 v14, 4, v236
    v_lshlrev_b32 v236, 8, v236
    v_add_u32 v238, 16, v236
    v_add_u32 v239, 10112, v2
    v_lshrrev_b32 v237, 3, v1
    v_cmp_eq_u32 vcc, s70, v237
    v_and_b32 v234, 1, v241
    v_lshl_add_u32 v4, v234, 3, v238
    v_cndmask_b32 v244, v239, v238, vcc
    s_waitcnt vmcnt(7)
    s_cmp_lg_u32 s72, 0
    s_cbranch_scc1 L_xs_done
    ds_write_b128 v244, v[216:219]
L_xs_done:
    v_dot2_f32_bf16 v228, v216, s7, 0
    v_dot2_f32_bf16 v229, v216, v216, 0
    v_dot2_f32_bf16 v228, v217, s7, v228
    v_dot2_f32_bf16 v229, v217, v217, v229
    v_dot2_f32_bf16 v228, v218, s7, v228
    v_dot2_f32_bf16 v229, v218, v218, v229
    v_dot2_f32_bf16 v228, v219, s7, v228
    v_dot2_f32_bf16 v229, v219, v219, v229
    s_waitcnt vmcnt(6)
    buffer_load_dwordx4 v[44:47], v246, s[28:31], s93 offen offset:0 nt
    v_add_f32_dpp v228, v228, v228 quad_perm:[1,0,3,2] row_mask:0xf bank_mask:0xf
    v_add_f32_dpp v229, v229, v229 quad_perm:[1,0,3,2] row_mask:0xf bank_mask:0xf
    s_nop 0
    v_add_f32_dpp v228, v228, v228 quad_perm:[2,3,0,1] row_mask:0xf bank_mask:0xf
    v_add_f32_dpp v229, v229, v229 quad_perm:[2,3,0,1] row_mask:0xf bank_mask:0xf
    s_nop 0
    v_add_f32_dpp v228, v228, v228 row_half_mirror row_mask:0xf bank_mask:0xf
    v_add_f32_dpp v229, v229, v229 row_half_mirror row_mask:0xf bank_mask:0xf
    s_nop 0
    v_add_f32_dpp v228, v228, v228 row_mirror row_mask:0xf bank_mask:0xf
    v_add_f32_dpp v229, v229, v229 row_mirror row_mask:0xf bank_mask:0xf
    s_nop 1
    v_permlane16_swap_b32 v228, v229
    v_add_f32 v228, v228, v229
    v_mov_b32 v229, v228
    s_nop 1
    v_permlane32_swap_b32 v228, v229
    v_add_f32 v228, v228, v229
    v_mov_b32 v229, v228
    s_nop 1
    v_permlane16_swap_b32 v228, v229
    s_waitcnt vmcnt(6)
    buffer_load_dwordx4 v[48:51], v246, s[28:31], s93 offen offset:256 nt
    s_add_u32 s93, s93, 65536
    s_and_b32 s93, s93, 0x3ffff
    s_waitcnt vmcnt(6)
    buffer_load_dwordx4 v[52:55], v246, s[28:31], s93 offen offset:0 nt
    s_waitcnt vmcnt(6)
    buffer_load_dwordx4 v[56:59], v246, s[28:31], s93 offen offset:256 nt
    s_add_u32 s93, s93, 65536
    s_and_b32 s93, s93, 0x3ffff
    s_waitcnt vmcnt(7)
    s_waitcnt lgkmcnt(0)
    s_barrier
    ds_read_b64_tr_b16 v[100:101], v233 offset:12288
    ds_read_b64_tr_b16 v[102:103], v233 offset:13312
    ds_read_b64_tr_b16 v[104:105], v233 offset:20480
    ds_read_b64_tr_b16 v[106:107], v233 offset:21504
    ds_read_b64_tr_b16 v[108:109], v233 offset:12296
    ds_read_b64_tr_b16 v[110:111], v233 offset:13320
    ds_read_b64_tr_b16 v[112:113], v233 offset:20488
    ds_read_b64_tr_b16 v[114:115], v233 offset:21512
    ds_read_b128 v[212:215], v2 offset:16
    ds_read_b128 v[216:219], v2 offset:1040
    ds_read_b128 v[220:223], v2 offset:0
    ds_read_b128 v[224:227], v2 offset:1024
    v_mul_f32 v230, 0x3b000000, v228
    v_mul_f32 v231, 0x3b000000, v229
    v_fma_f32 v231, -v230, v230, v231
    v_max_f32 v231, 0, v231
    v_add_f32 v231, 0x3727c5ac, v231
    v_rsq_f32 v231, v231
    s_waitcnt vmcnt(4)
    v_readfirstlane_b32 s73, v191
    s_mul_i32 s73, s73, 0x9e3779b1
    s_add_u32 s73, s73, 0x7f4a7c15
    s_lshl_b32 s79, s66, 3
    s_add_u32 s79, s79, s70
    s_lshl_b32 s79, s79, 9
    s_add_u32 s79, s79, 0x9000
    v_mul_f32 v230, v230, -v231
    s_waitcnt lgkmcnt(3)
    v_mfma_f32_16x16x32_bf16 v[208:211], v[100:103], v[212:215], 0
    s_waitcnt lgkmcnt(2)
    v_mfma_f32_16x16x32_bf16 v[208:211], v[104:107], v[216:219], v[208:211]
    s_waitcnt lgkmcnt(1)
    v_mfma_f32_16x16x32_bf16 v[208:211], v[108:111], v[220:223], v[208:211]
    s_waitcnt lgkmcnt(0)
    v_mfma_f32_16x16x32_bf16 v[208:211], v[112:115], v[224:227], v[208:211]
    v_mov_b32 v213, s73
    v_mov_b32 v215, s73
    s_nop 5
    v_mul_f32 v216, v231, v208
    v_mul_f32 v217, v231, v209
    v_mul_f32 v218, v231, v210
    v_mul_f32 v219, v231, v211
    v_fmac_f32_dpp v216, v208, v230 quad_perm:[2,3,2,3] row_mask:0xf bank_mask:0xf
    v_fmac_f32_dpp v217, v209, v230 quad_perm:[2,3,2,3] row_mask:0xf bank_mask:0xf
    v_fmac_f32_dpp v218, v210, v230 quad_perm:[2,3,2,3] row_mask:0xf bank_mask:0xf
    v_fmac_f32_dpp v219, v211, v230 quad_perm:[2,3,2,3] row_mask:0xf bank_mask:0xf
    v_cvt_pk_bf16_f32 v212, v216, v217
    v_cvt_pk_bf16_f32 v214, v218, v219
    buffer_store_dwordx4 v[212:215], v5, s[36:39], s79 offen
    s_waitcnt vmcnt(7)
    buffer_load_dwordx4 v[60:63], v246, s[28:31], s93 offen offset:0 nt
    s_waitcnt vmcnt(7)
    buffer_load_dwordx4 v[64:67], v246, s[28:31], s93 offen offset:256 nt
    s_add_u32 s93, s93, 65536
    s_and_b32 s93, s93, 0x3ffff
    s_getreg_b32 s78, hwreg(HW_REG_XCC_ID, 0, 4)
    s_and_b32 s74, s73, 0xfffffff0
    s_or_b32 s74, s74, s78
    s_bfe_u32 s94, s78, 0x10002
    s_xor_b32 s94, s94, 1
    s_lshl_b32 s94, s94, 13
    v_lshlrev_b32 v236, 7, v1
    s_lshl_b32 s78, s72, 13
    s_add_u32 s78, s78, 0x1000
    v_add_u32 v206, s78, v236
    s_lshl_b32 s78, s68, 12
    s_add_u32 s78, s78, 0x1000
    s_cmp_eq_u32 s72, 1
    s_cselect_b32 s78, s78, 0x80000000
    v_and_b32 v236, 0xf80, v236
    v_add_u32 v205, s78, v236
    s_mov_b32 s4, 0x00003f80
    s_mov_b32 s5, 0x3f800000
    s_mov_b32 s6, 0x3e0293ee
    s_mov_b32 s76, 0
    s_mov_b32 s75, 0
    s_mov_b32 s89, 0
    s_cmp_eq_u32 s68, s70
    s_cselect_b32 s90, s71, 0
    s_cmp_eq_u32 s90, 3
    s_cselect_b32 s90, 1, 0
    s_mul_i32 s78, s71, 2176
    s_add_u32 s84, s83, s78
    s_add_u32 s84, s84, 0x8200
    s_mov_b32 s86, 0xac000
    s_mov_b32 s87, 0xb8000
    s_mul_i32 s78, s70, 16384
    s_add_u32 s88, s87, s78
    s_lshl_b32 s78, s71, 12
    s_add_u32 s92, s83, s78
    s_lshl_b32 s78, s70, 9
    s_add_u32 s91, s92, s78
    v_and_b32 v236, 1, v1
    v_cmp_eq_u32 vcc, 1, v236
    v_mov_b32 v237, 0xffff
    v_mov_b32 v238, 0xffff0000
    v_cndmask_b32 v237, v237, v238, vcc
    v_bfe_u32 v236, v1, 1, 2
    v_cmp_eq_u32 vcc, 0, v236
    s_nop 1
    v_cndmask_b32 v28, 0, v237, vcc
    v_and_b32 v32, 0x3f803f80, v28
    v_cmp_eq_u32 vcc, 1, v236
    s_nop 1
    v_cndmask_b32 v29, 0, v237, vcc
    v_and_b32 v33, 0x3f803f80, v29
    v_cmp_eq_u32 vcc, 2, v236
    s_nop 1
    v_cndmask_b32 v30, 0, v237, vcc
    v_and_b32 v34, 0x3f803f80, v30
    v_cmp_eq_u32 vcc, 3, v236
    s_nop 1
    v_cndmask_b32 v31, 0, v237, vcc
    v_and_b32 v35, 0x3f803f80, v31
    v_and_b32 v236, 4, v1
    v_cmp_eq_u32 vcc, 0, v236
    v_mov_b32 v237, 0xffff
    v_add_u32 v236, 1, v243
    v_cndmask_b32 v28, 0, v237, vcc
    v_xor_b32 v29, v237, v28
    v_and_b32 v236, 3, v236
    v_lshl_add_u32 v236, v236, 2, v243
    v_mul_u32_u24 v30, 0x1111, v236
    v_bfe_u32 v237, v1, 3, 2
    v_lshlrev_b32 v237, 8, v237
    v_lshrrev_b32 v239, 1, v14
    v_add_u32 v237, v237, v239
    v_lshrrev_b32 v239, 5, v1
    v_lshl_add_u32 v237, v239, 1, v237
    v_add_u32 v6, 2496, v237
    s_lshl_b32 s78, s72, 9
    s_add_u32 s78, s78, 6976
    v_lshlrev_b32 v237, 5, v240
    v_lshl_add_u32 v237, v234, 4, v237
    v_add_u32 v7, s78, v237
    v_lshlrev_b32 v3, 3, v1
    v_add_u32 v237, 10112, v3
    s_lshl_b32 s78, s72, 3
    s_add_u32 s78, s78, 9024
    v_mov_b32 v239, s78
    v_cmp_eq_u32 vcc, 0, v1
    s_nop 1
    v_cndmask_b32 v8, v237, v239, vcc
    s_lshl_b32 s78, s70, 4
    v_lshrrev_b32 v237, 2, v1
    v_lshlrev_b32 v237, 7, v237
    v_lshl_add_u32 v237, v243, 2, v237
    v_add_u32 v9, s78, v237
    s_cmp_eq_u32 s72, 0
    s_cselect_b32 s79, s78, 0x80000000
    v_or_b32 v15, s79, v13
    s_add_u32 s78, s78, 2048
    v_add_u32 v10, s78, v13
    v_cmp_gt_u32 vcc, 32, v1
    v_mov_b32 v247, 0x80000000
    s_nop 0
    v_cndmask_b32 v11, v247, v2, vcc
    v_cmp_gt_u32 vcc, 8, v1
    v_mov_b32 v247, 0x80000000
    s_nop 0
    v_cndmask_b32 v16, v247, v2, vcc
    v_lshlrev_b32 v237, 4, v240
    v_lshl_add_u32 v237, v241, 3, v237
    v_and_b32 v239, 0x28, v1
    v_cmp_eq_u32 vcc, 0, v239
    v_mov_b32 v247, 0x80000000
    s_nop 0
    v_cndmask_b32 v12, v247, v237, vcc
    s_cmp_eq_u32 s81, 1
    s_cbranch_scc0 L_ra_notO
    s_and_b32 s78, s72, 1
    s_lshl_b32 s78, s78, 10
    v_lshlrev_b32 v236, 7, v241
    v_lshl_add_u32 v236, v240, 4, v236
    v_add_u32 v236, s78, v236
    v_lshl_add_u32 v239, v241, 2, v240
    v_and_b32 v239, 7, v239
    v_lshlrev_b32 v239, 4, v239
    v_add_u32 v239, 2048, v239
    v_cmp_gt_u32 vcc, 8, v240
    s_nop 1
    v_cndmask_b32 v17, v239, v236, vcc
    v_add_u32 v236, 512, v236
    v_cmp_gt_u32 vcc, 8, v240
    v_mov_b32 v247, 0x80000000
    s_nop 0
    v_cndmask_b32 v18, v247, v236, vcc
    s_lshl_b32 s78, s72, 8
    s_add_u32 s78, s78, 9088
    v_lshlrev_b32 v236, 2, v1
    v_add_u32 v19, s78, v236
    v_and_b32 v21, 0x7c, v236
    v_lshrrev_b32 v239, 5, v1
    v_lshl_add_u32 v21, v239, 13, v21
    v_and_b32 v20, 0xf8, v3
    s_lshl_b32 s78, s72, 13
    s_add_u32 s78, s78, 28672
    v_lshlrev_b32 v236, 7, v203
    v_lshl_add_u32 v236, v243, 3, v236
    v_lshrrev_b32 v239, 1, v242
    v_lshl_add_u32 v239, v234, 1, v239
    v_lshl_add_u32 v236, v239, 5, v236
    v_add_u32 v22, s78, v236
    s_lshl_b32 s78, s72, 16
    v_lshrrev_b32 v236, 3, v1
    v_lshlrev_b32 v239, 5, v234
    v_xor_b32 v239, v239, v14
    v_lshl_add_u32 v236, v236, 10, v239
    v_add_u32 v23, s78, v236
    v_xor_b32 v24, 64, v23
    v_mov_b32 v25, 0
    v_mov_b32 v27, 0
    s_lshr_b32 s78, s82, 3
    s_lshl_b32 s79, s78, 1
    s_lshr_b32 s77, s72, 1
    s_add_u32 s79, s79, s77
    s_mul_i32 s79, s79, 2176
    s_add_u32 s79, s79, s83
    s_add_u32 s85, s79, 0x8200
    s_lshl_b32 s79, s68, 1
    s_add_u32 s78, s78, s79
    s_and_b32 s79, s78, 8
    s_add_u32 s78, s78, s79
    s_lshl_b32 s78, s78, 10
    s_and_b32 s79, s82, 7
    s_lshl_b32 s79, s79, 7
    s_add_u32 s78, s78, s79
    v_add_u32 v21, s78, v21
    s_branch L_ra_done
L_ra_notO:
    s_mov_b32 s85, 0
    s_lshl_b32 s78, s72, 8
    v_lshlrev_b32 v236, 4, v240
    v_add_u32 v236, s78, v236
    v_lshl_add_u32 v17, v241, 10, v236
    v_cmp_gt_u32 vcc, 16, v1
    v_mov_b32 v247, 0x80000000
    s_nop 0
    v_cndmask_b32 v18, v247, v236, vcc
    v_lshl_add_u32 v19, v240, 1, v234
    v_lshlrev_b32 v19, 2, v19
    v_add_u32 v19, s78, v19
    v_add_u32 v19, 4864, v19
    v_bfe_u32 v239, v1, 1, 1
    v_mul_u32_u24 v27, 0xaaaa, v239
    v_add_u32 v27, 0x4444, v27
    v_lshlrev_b32 v236, 4, v241
    v_add_u32 v239, 1088, v236
    v_add_u32 v236, s78, v236
    v_and_b32 v20, 2, v1
    v_lshl_add_u32 v236, v20, 6, v236
    v_and_b32 v20, 1, v1
    v_cmp_eq_u32 vcc, 1, v20
    s_nop 1
    v_cndmask_b32 v20, v236, v239, vcc
    v_lshlrev_b32 v236, 1, v240
    v_lshl_add_u32 v236, v241, 8, v236
    v_add_u32 v236, 3696, v236
    v_lshlrev_b32 v239, 1, v1
    v_add_u32 v239, 10112, v239
    v_cmp_gt_u32 vcc, 8, v240
    s_nop 1
    v_cndmask_b32 v21, v239, v236, vcc
    s_lshl_b32 s78, s72, 9
    v_lshlrev_b32 v236, 3, v240
    v_add_u32 v25, s78, v236
    s_mul_i32 s78, s72, 32768
    s_lshl_b32 s79, s82, 7
    s_add_u32 s78, s78, s79
    v_lshlrev_b32 v236, 13, v241
    v_add3_u32 v236, v236, v14, s78
    v_cmp_gt_u32 vcc, 8, v240
    v_mov_b32 v247, 0x80000000
    s_nop 0
    v_cndmask_b32 v22, v247, v236, vcc
    v_bfe_u32 v236, v1, 3, 1
    v_mul_u32_u24 v236, 16384, v236
    v_add_u32 v236, v236, v14
    v_lshl_add_u32 v236, v234, 3, v236
    s_mul_i32 s78, s72, 32768
    s_add_u32 s78, s78, 5504
    s_cmp_eq_u32 s82, 0
    s_cselect_b32 s78, s78, 0x80000000
    v_lshrrev_b32 v239, 5, v1
    v_lshl_add_u32 v236, v239, 13, v236
    v_add_u32 v23, s78, v236
    s_xor_b32 s78, s68, 1
    s_lshl_b32 s78, s78, 1
    s_add_u32 s78, s78, 1
    s_and_b32 s79, s78, 8
    s_add_u32 s78, s78, s79
    s_lshl_b32 s78, s78, 10
    s_lshl_b32 s79, s72, 8
    s_add_u32 s78, s78, s79
    v_add_u32 v24, s78, v16
L_ra_done:
    s_cmp_lg_u32 s72, 0
    s_cbranch_scc1 L_v_other
    s_waitcnt vmcnt(6)
    buffer_load_dwordx4 v[68:71], v235, s[32:35], s93 offen nt
    s_add_u32 s93, s93, 32768
    s_and_b32 s93, s93, 0x3ffff
    s_waitcnt vmcnt(6)
    buffer_load_dwordx4 v[72:75], v235, s[32:35], s93 offen nt
    s_add_u32 s93, s93, 32768
    s_and_b32 s93, s93, 0x3ffff
    s_waitcnt vmcnt(6)
    buffer_load_dwordx4 v[76:79], v235, s[32:35], s93 offen nt
    s_add_u32 s93, s93, 32768
    s_and_b32 s93, s93, 0x3ffff
    s_lshl_b32 s79, s66, 12
    s_add_u32 s79, s79, 0x9000
    buffer_load_dwordx4 v[212:215], v2, s[36:39], s79 offen offset:0 sc1
    buffer_load_dwordx4 v[216:219], v2, s[36:39], s79 offen offset:1024 sc1
    buffer_load_dwordx4 v[220:223], v2, s[36:39], s79 offen offset:2048 sc1
    buffer_load_dwordx4 v[224:227], v2, s[36:39], s79 offen offset:3072 sc1
    s_waitcnt vmcnt(10)
    buffer_load_dwordx4 v[80:83], v235, s[32:35], s93 offen nt
    s_add_u32 s93, s93, 32768
    s_and_b32 s93, s93, 0x3ffff
    s_waitcnt vmcnt(9)
    buffer_load_dwordx4 v[84:87], v235, s[32:35], s93 offen nt
    s_add_u32 s93, s93, 32768
    s_and_b32 s93, s93, 0x3ffff
    buffer_load_dwordx4 v[116:119], v2, s[36:39], s79 offen offset:0 sc1
    buffer_load_dwordx4 v[120:123], v2, s[36:39], s79 offen offset:1024 sc1
    buffer_load_dwordx4 v[124:127], v2, s[36:39], s79 offen offset:2048 sc1
    buffer_load_dwordx4 v[128:131], v2, s[36:39], s79 offen offset:3072 sc1
    s_waitcnt vmcnt(13)
    buffer_load_dwordx4 v[88:91], v235, s[32:35], s93 offen nt
    s_add_u32 s93, s93, 32768
    s_and_b32 s93, s93, 0x3ffff
    s_waitcnt vmcnt(13)
    buffer_load_dwordx4 v[92:95], v235, s[32:35], s93 offen nt
    s_add_u32 s93, s93, 32768
    s_and_b32 s93, s93, 0x3ffff
    buffer_load_dwordx2 v[200:201], v205, s[36:39], 0 offen sc1
    buffer_load_dwordx4 v[132:135], v2, s[36:39], s79 offen offset:0 sc1
    buffer_load_dwordx4 v[136:139], v2, s[36:39], s79 offen offset:1024 sc1
    buffer_load_dwordx4 v[140:143], v2, s[36:39], s79 offen offset:2048 sc1
    buffer_load_dwordx4 v[144:147], v2, s[36:39], s79 offen offset:3072 sc1
    s_waitcnt vmcnt(18)
    buffer_load_dwordx4 v[96:99], v235, s[32:35], s93 offen nt
    s_add_u32 s93, s93, 32768
    s_and_b32 s93, s93, 0x3ffff
    s_mov_b32 s77, 524288
    s_mov_b32 s78, 1
    s_waitcnt vmcnt(14)
L_pq1_chk:
    v_xor_b32 v228, s73, v213
    v_bitop3_b32 v228, v215, s73, v228 bitop3:0xbe
    v_bitop3_b32 v228, v217, s73, v228 bitop3:0xbe
    v_bitop3_b32 v228, v219, s73, v228 bitop3:0xbe
    v_bitop3_b32 v228, v221, s73, v228 bitop3:0xbe
    v_bitop3_b32 v228, v223, s73, v228 bitop3:0xbe
    v_bitop3_b32 v228, v225, s73, v228 bitop3:0xbe
    v_bitop3_b32 v228, v227, s73, v228 bitop3:0xbe
    v_cmp_ne_u32 vcc, 0, v228
    s_cbranch_vccnz L_pq1_retry
L_pq1_ok:
    v_dot2_f32_bf16 v228, v212, s4, 0
    v_dot2_f32_bf16 v229, v212, s5, 0
    v_dot2_f32_bf16 v230, v214, s4, 0
    v_dot2_f32_bf16 v231, v214, s5, 0
    v_dot2_f32_bf16 v228, v216, s4, v228
    v_dot2_f32_bf16 v229, v216, s5, v229
    v_dot2_f32_bf16 v230, v218, s4, v230
    v_dot2_f32_bf16 v231, v218, s5, v231
    v_dot2_f32_bf16 v228, v220, s4, v228
    v_dot2_f32_bf16 v229, v220, s5, v229
    v_dot2_f32_bf16 v230, v222, s4, v230
    v_dot2_f32_bf16 v231, v222, s5, v231
    v_dot2_f32_bf16 v228, v224, s4, v228
    v_dot2_f32_bf16 v229, v224, s5, v229
    v_dot2_f32_bf16 v230, v226, s4, v230
    v_dot2_f32_bf16 v231, v226, s5, v231
    s_nop 0
    v_permlane32_swap_b32 v228, v229
    s_nop 0
    v_permlane32_swap_b32 v230, v231
    v_add_f32 v228, v228, v229
    v_add_f32 v230, v230, v231
    v_cvt_pk_bf16_f32 v228, v228, v230
    ds_write_b16 v6, v228
    ds_write_b16_d16_hi v6, v228 offset:4
    s_branch L_v_done
L_v_other:
    s_waitcnt vmcnt(6)
    buffer_load_dwordx4 v[68:71], v235, s[32:35], s93 offen nt
    s_add_u32 s93, s93, 32768
    s_and_b32 s93, s93, 0x3ffff
    s_waitcnt vmcnt(6)
    buffer_load_dwordx4 v[72:75], v235, s[32:35], s93 offen nt
    s_add_u32 s93, s93, 32768
    s_and_b32 s93, s93, 0x3ffff
    s_waitcnt vmcnt(6)
    buffer_load_dwordx4 v[76:79], v235, s[32:35], s93 offen nt
    s_add_u32 s93, s93, 32768
    s_and_b32 s93, s93, 0x3ffff
    s_waitcnt vmcnt(6)
    buffer_load_dwordx4 v[80:83], v235, s[32:35], s93 offen nt
    s_add_u32 s93, s93, 32768
    s_and_b32 s93, s93, 0x3ffff
    s_waitcnt vmcnt(5)
    buffer_load_dwordx4 v[84:87], v235, s[32:35], s93 offen nt
    s_add_u32 s93, s93, 32768
    s_and_b32 s93, s93, 0x3ffff
    s_waitcnt vmcnt(5)
    buffer_load_dwordx4 v[88:91], v235, s[32:35], s93 offen nt
    s_add_u32 s93, s93, 32768
    s_and_b32 s93, s93, 0x3ffff
    s_waitcnt vmcnt(5)
    buffer_load_dwordx4 v[92:95], v235, s[32:35], s93 offen nt
    s_add_u32 s93, s93, 32768
    s_and_b32 s93, s93, 0x3ffff
    buffer_load_dwordx2 v[200:201], v205, s[36:39], 0 offen sc1
    s_waitcnt vmcnt(6)
    buffer_load_dwordx4 v[96:99], v235, s[32:35], s93 offen nt
    s_add_u32 s93, s93, 32768
    s_and_b32 s93, s93, 0x3ffff
L_v_done:
L_layer_bar:
    s_waitcnt lgkmcnt(0)
    s_barrier
L_layer:
    ds_read_b128 v[212:215], v2 offset:2496
    ds_read_b128 v[216:219], v2 offset:2432
    ds_read_b128 v[220:223], v2 offset:2368
    ds_read_b128 v[224:227], v2 offset:2304
    s_waitcnt vmcnt(9)
    s_waitcnt lgkmcnt(3)
    v_mfma_f32_16x16x32_bf16 v[228:231], v[36:39], v[212:215], 0
    v_mfma_f32_16x16x32_bf16 v[232:235], v[52:55], v[212:215], 0
    s_waitcnt lgkmcnt(2)
    v_mfma_f32_16x16x32_bf16 v[228:231], v[40:43], v[216:219], v[228:231]
    v_mfma_f32_16x16x32_bf16 v[232:235], v[56:59], v[216:219], v[232:235]
    s_waitcnt lgkmcnt(1)
    v_mfma_f32_16x16x32_bf16 v[228:231], v[44:47], v[220:223], v[228:231]
    v_mfma_f32_16x16x32_bf16 v[232:235], v[60:63], v[220:223], v[232:235]
    s_waitcnt lgkmcnt(0)
    v_mfma_f32_16x16x32_bf16 v[228:231], v[48:51], v[224:227], v[228:231]
    v_mfma_f32_16x16x32_bf16 v[232:235], v[64:67], v[224:227], v[232:235]
    v_mov_b32 v244, 0
    v_mov_b32 v245, 0
    v_mov_b32 v246, 0
    v_mov_b32 v247, 0
    s_nop 2
    v_mov_b32_dpp v236, v228 quad_perm:[0,0,0,0] row_mask:0xf bank_mask:0xf
    v_mov_b32_dpp v237, v232 quad_perm:[0,0,0,0] row_mask:0xf bank_mask:0xf
    s_nop 0
    v_add_f32_dpp v236, v229, v236 quad_perm:[1,1,1,1] row_mask:0xf bank_mask:0xf
    v_add_f32_dpp v237, v233, v237 quad_perm:[1,1,1,1] row_mask:0xf bank_mask:0xf
    s_nop 0
    v_add_f32_dpp v236, v230, v236 quad_perm:[2,2,2,2] row_mask:0xf bank_mask:0xf
    v_add_f32_dpp v237, v234, v237 quad_perm:[2,2,2,2] row_mask:0xf bank_mask:0xf
    s_nop 0
    v_add_f32_dpp v236, v231, v236 quad_perm:[3,3,3,3] row_mask:0xf bank_mask:0xf
    v_add_f32_dpp v237, v235, v237 quad_perm:[3,3,3,3] row_mask:0xf bank_mask:0xf
    v_max_f32 v240, v236, v237
    s_nop 1
    v_max_f32_dpp v240, v240, v240 row_ror:4 row_mask:0xf bank_mask:0xf
    s_nop 1
    v_max_f32_dpp v240, v240, v240 row_ror:8 row_mask:0xf bank_mask:0xf
    v_mov_b32 v238, v240
    s_nop 1
    v_permlane16_swap_b32 v240, v238
    v_max_f32 v240, v240, v238
    v_mov_b32 v238, v240
    s_nop 1
    v_permlane32_swap_b32 v240, v238
    v_max_f32 v240, v240, v238
    v_mul_f32 v240, s6, v240
    v_fma_f32 v236, v236, s6, -v240
    v_fma_f32 v237, v237, s6, -v240
    v_exp_f32 v236, v236
    v_exp_f32 v237, v237
    v_cvt_pk_bf16_f32 v242, v236, v236
    v_cvt_pk_bf16_f32 v243, v237, v237
    v_add_f32 v241, v236, v237
    v_and_b32_dpp v212, v242, v28 row_newbcast:0 row_mask:0xf bank_mask:0xf
    v_and_b32_dpp v213, v242, v29 row_newbcast:0 row_mask:0xf bank_mask:0xf
    v_and_b32_dpp v214, v242, v28 row_newbcast:4 row_mask:0xf bank_mask:0xf
    v_and_b32_dpp v215, v242, v29 row_newbcast:4 row_mask:0xf bank_mask:0xf
    v_and_b32_dpp v216, v242, v28 row_newbcast:8 row_mask:0xf bank_mask:0xf
    v_and_b32_dpp v217, v242, v29 row_newbcast:8 row_mask:0xf bank_mask:0xf
    v_and_b32_dpp v218, v242, v28 row_newbcast:12 row_mask:0xf bank_mask:0xf
    v_and_b32_dpp v219, v242, v29 row_newbcast:12 row_mask:0xf bank_mask:0xf
    s_waitcnt vmcnt(7)
    v_smfmac_f32_16x16x64_bf16 v[244:247], v[212:215], v[68:75], v30
    v_add_f32_dpp v241, v241, v241 row_ror:4 row_mask:0xf bank_mask:0xf
    v_and_b32_dpp v212, v243, v28 row_newbcast:0 row_mask:0xf bank_mask:0xf
    v_and_b32_dpp v213, v243, v29 row_newbcast:0 row_mask:0xf bank_mask:0xf
    v_and_b32_dpp v214, v243, v28 row_newbcast:4 row_mask:0xf bank_mask:0xf
    v_and_b32_dpp v215, v243, v29 row_newbcast:4 row_mask:0xf bank_mask:0xf
    s_waitcnt vmcnt(5)
    v_smfmac_f32_16x16x64_bf16 v[244:247], v[216:219], v[76:83], v30
    v_add_f32_dpp v241, v241, v241 row_ror:8 row_mask:0xf bank_mask:0xf
    v_and_b32_dpp v216, v243, v28 row_newbcast:8 row_mask:0xf bank_mask:0xf
    v_and_b32_dpp v217, v243, v29 row_newbcast:8 row_mask:0xf bank_mask:0xf
    v_and_b32_dpp v218, v243, v28 row_newbcast:12 row_mask:0xf bank_mask:0xf
    v_and_b32_dpp v219, v243, v29 row_newbcast:12 row_mask:0xf bank_mask:0xf
    s_waitcnt vmcnt(3)
    v_smfmac_f32_16x16x64_bf16 v[244:247], v[212:215], v[84:91], v30
    v_mov_b32 v238, v241
    s_nop 1
    v_permlane16_swap_b32 v241, v238
    v_add_f32 v241, v241, v238
    s_waitcnt vmcnt(0)
    v_smfmac_f32_16x16x64_bf16 v[244:247], v[216:219], v[92:99], v30
    v_mov_b32 v238, v241
    s_nop 1
    v_permlane32_swap_b32 v241, v238
    v_add_f32 v241, v241, v238
    ds_write_b64 v8, v[240:241]
    s_cmp_lg_u32 s76, 0
    s_cbranch_scc1 L_hello_done
    s_cmp_lg_u32 s72, 1
    s_cbranch_scc1 L_hello_skip
    s_mov_b32 s77, 524288
L_hello_chk:
    v_xor_b32 v238, s74, v200
    v_cmp_lt_u32 vcc, 15, v238
    v_cmp_ne_u32 s[64:65], 0, v238
    s_cbranch_vccnz L_hello_retry
L_hello_ok:
    s_cmp_eq_u64 s[64:65], 0
    s_cselect_b32 s75, 1, 0
    v_cmp_lt_i32 vcc, 0, v201
    v_cmp_gt_i32 s[64:65], 0, v201
    s_bcnt1_i32_b64 s78, vcc
    s_bcnt1_i32_b64 s79, s[64:65]
    s_cmp_gt_u32 s78, s79
    s_cselect_b32 s94, 8192, s94
    s_cmp_lt_u32 s78, s79
    s_cselect_b32 s94, 0, s94
    s_or_b32 s78, s75, s94
    v_mov_b32 v238, s78
    v_mov_b32 v239, 9056
    ds_write_b32 v239, v238
L_hello_skip:
    s_cmp_eq_u32 s81, 1
    s_cbranch_scc0 L_early_notO
    s_lshl_b32 s78, s72, 13
    s_add_u32 m0, s78, 28672
    s_mov_b32 s79, 0
    buffer_load_dwordx4 v23, s[48:51], s79 offen nt lds
    s_add_u32 s79, s79, 8192
    s_add_u32 m0, m0, 1024
    s_nop 0
    buffer_load_dwordx4 v24, s[48:51], s79 offen nt lds
    s_add_u32 s79, s79, 8192
    s_add_u32 m0, m0, 1024
    s_nop 0
    buffer_load_dwordx4 v23, s[48:51], s79 offen nt lds
    s_add_u32 s79, s79, 8192
    s_add_u32 m0, m0, 1024
    s_nop 0
    buffer_load_dwordx4 v24, s[48:51], s79 offen nt lds
    s_add_u32 s79, s79, 8192
    s_add_u32 m0, m0, 1024
    s_nop 0
    buffer_load_dwordx4 v23, s[48:51], s79 offen nt lds
    s_add_u32 s79, s79, 8192
    s_add_u32 m0, m0, 1024
    s_nop 0
    buffer_load_dwordx4 v24, s[48:51], s79 offen nt lds
    s_add_u32 s79, s79, 8192
    s_add_u32 m0, m0, 1024
    s_nop 0
    buffer_load_dwordx4 v23, s[48:51], s79 offen nt lds
    s_add_u32 s79, s79, 8192
    s_add_u32 m0, m0, 1024
    s_nop 0
    buffer_load_dwordx4 v24, s[48:51], s79 offen nt lds
L_early_notO:
L_hello_done:
    s_nop 3
    ds_write_b128 v7, v[244:247]
    v_mov_b32 v228, 9024
    s_cmp_lg_u32 s72, 0
    s_cbranch_scc1 L_p1_not0
    s_waitcnt lgkmcnt(0)
    s_barrier
    ds_read_b128 v[212:215], v228
    ds_read_b128 v[216:219], v228 offset:16
    ds_read_b32 v229, v228 offset:32
    ds_read_b64 v[220:221], v3 offset:6976
    ds_read_b64 v[222:223], v3 offset:7488
    ds_read_b64 v[224:225], v3 offset:8000
    ds_read_b64 v[226:227], v3 offset:8512
    s_waitcnt lgkmcnt(4)
    v_max3_f32 v228, v212, v214, v216
    v_readfirstlane_b32 s94, v229
    v_max_f32 v228, v228, v218
    v_sub_f32 v212, v212, v228
    v_sub_f32 v214, v214, v228
    v_sub_f32 v216, v216, v228
    v_sub_f32 v218, v218, v228
    v_exp_f32 v212, v212
    v_exp_f32 v214, v214
    v_exp_f32 v216, v216
    v_exp_f32 v218, v218
    s_and_b32 s75, s94, 1
    s_waitcnt lgkmcnt(0)
    v_pk_mul_f32 v[232:233], v[212:213], v[220:221] op_sel_hi:[0,1]
    v_pk_fma_f32 v[232:233], v[214:215], v[222:223], v[232:233] op_sel_hi:[0,1,1]
    v_pk_fma_f32 v[232:233], v[216:217], v[224:225], v[232:233] op_sel_hi:[0,1,1]
    v_pk_fma_f32 v[232:233], v[218:219], v[226:227], v[232:233] op_sel_hi:[0,1,1]
    v_cvt_pk_bf16_f32 v232, v232, v233
    s_cbranch_scc0 L_slow_1
    buffer_store_dword v232, v9, s[36:39], s84 offen
L_done_2:
L_p1_done:
    s_lshr_b32 s61, s94, 16
    s_and_b32 s94, s94, 8192
    s_cmp_lg_u32 s76, 0
    s_cbranch_scc1 L_extras_done
    s_cmp_eq_u32 s75, 0
    s_cbranch_scc1 L_slow_5
    buffer_store_dwordx4 v[208:211], v202, s[36:39], s91 offen
L_done_6:
    s_lshl_b32 s78, s75, 8
    s_or_b32 s78, s78, s72
    s_cmp_eq_u32 s78, 2
    s_cbranch_scc1 L_ex_through
L_ex_through_done:
    s_cmp_eq_u32 s81, 1
    s_cbranch_scc0 L_ex_notO
    s_branch L_extras_done
L_ex_notO:
    s_cmp_eq_u32 s81, 2
    s_cbranch_scc0 L_ex_notB
L_ex_B:
    v_lshrrev_b32 v236, 2, v1
    s_lshl_b32 s78, s72, 7
    v_add_u32 v236, s78, v236
    v_mul_u32_u24 v236, 2752, v236
    v_and_b32 v238, 3, v1
    v_lshrrev_b32 v239, 5, v1
    v_lshlrev_b32 v239, 1, v239
    v_xor_b32 v239, v239, v238
    v_lshl_add_u32 v236, v239, 4, v236
    v_xor_b32 v237, 16, v236
    v_lshrrev_b32 v239, 4, v1
    v_lshlrev_b32 v239, 4, v239
    v_xor_b32 v244, v239, v17
    v_xor_b32 v245, 64, v244
    s_lshl_b32 s78, s72, 13
    s_add_u32 m0, s78, 28672
    s_mov_b32 s79, 0
    s_barrier
    buffer_load_dwordx4 v[228:231], v18, s[44:47], s89 offen
    buffer_load_dword v207, v206, s[36:39], 0 offen sc1
    buffer_load_dwordx4 v236, s[48:51], s79 offen lds
    s_add_u32 m0, m0, 32768
    s_nop 0
    buffer_load_dwordx4 v237, s[52:55], s79 offen lds
    s_sub_u32 m0, m0, 31744
    s_add_u32 s79, s79, 44032
    buffer_load_dwordx4 v236, s[48:51], s79 offen lds
    s_add_u32 m0, m0, 32768
    s_nop 0
    buffer_load_dwordx4 v237, s[52:55], s79 offen lds
    s_sub_u32 m0, m0, 31744
    s_add_u32 s79, s79, 44032
    buffer_load_dwordx4 v236, s[48:51], s79 offen lds
    s_add_u32 m0, m0, 32768
    s_nop 0
    buffer_load_dwordx4 v237, s[52:55], s79 offen lds
    s_sub_u32 m0, m0, 31744
    s_add_u32 s79, s79, 44032
    buffer_load_dwordx4 v236, s[48:51], s79 offen lds
    s_add_u32 m0, m0, 32768
    s_nop 0
    buffer_load_dwordx4 v237, s[52:55], s79 offen lds
    s_sub_u32 m0, m0, 31744
    s_add_u32 s79, s79, 44032
    buffer_load_dwordx4 v236, s[48:51], s79 offen lds
    s_add_u32 m0, m0, 32768
    s_nop 0
    buffer_load_dwordx4 v237, s[52:55], s79 offen lds
    s_sub_u32 m0, m0, 31744
    s_add_u32 s79, s79, 44032
    buffer_load_dwordx4 v236, s[48:51], s79 offen lds
    s_add_u32 m0, m0, 32768
    s_nop 0
    buffer_load_dwordx4 v237, s[52:55], s79 offen lds
    s_sub_u32 m0, m0, 31744
    s_add_u32 s79, s79, 44032
    buffer_load_dwordx4 v236, s[48:51], s79 offen lds
    s_add_u32 m0, m0, 32768
    s_nop 0
    buffer_load_dwordx4 v237, s[52:55], s79 offen lds
    s_sub_u32 m0, m0, 31744
    s_add_u32 s79, s79, 44032
    buffer_load_dwordx4 v236, s[48:51], s79 offen lds
    s_add_u32 m0, m0, 32768
    s_nop 0
    buffer_load_dwordx4 v237, s[52:55], s79 offen lds
    s_lshl_b32 s3, s72, 13
    s_add_u32 m0, s3, 94208
    s_mov_b32 s3, 0
    buffer_load_dwordx4 v244, s[56:59], s3 offen lds
    s_add_u32 s3, s3, 4096
    s_add_u32 m0, m0, 1024
    s_nop 0
    buffer_load_dwordx4 v244, s[56:59], s3 offen lds
    s_add_u32 s3, s3, 4096
    s_add_u32 m0, m0, 1024
    s_nop 0
    buffer_load_dwordx4 v245, s[56:59], s3 offen lds
    s_add_u32 s3, s3, 4096
    s_add_u32 m0, m0, 1024
    s_nop 0
    buffer_load_dwordx4 v245, s[56:59], s3 offen lds
    s_add_u32 s3, s3, 4096
    s_add_u32 m0, m0, 1024
    s_nop 0
    buffer_load_dwordx4 v244, s[56:59], s3 offen lds
    s_add_u32 s3, s3, 4096
    s_add_u32 m0, m0, 1024
    s_nop 0
    buffer_load_dwordx4 v244, s[56:59], s3 offen lds
    s_add_u32 s3, s3, 4096
    s_add_u32 m0, m0, 1024
    s_nop 0
    buffer_load_dwordx4 v245, s[56:59], s3 offen lds
    s_add_u32 s3, s3, 4096
    s_add_u32 m0, m0, 1024
    s_nop 0
    buffer_load_dwordx4 v245, s[56:59], s3 offen lds
    s_lshl_b32 s78, s72, 13
    v_bfe_u32 v216, v1, 4, 1
    v_and_b32 v239, 1, v238
    v_lshrrev_b32 v238, 1, v238
    v_lshl_add_u32 v246, v216, 1, v238
    v_lshlrev_b32 v246, 4, v246
    v_lshl_add_u32 v246, v203, 6, v246
    v_lshl_add_u32 v246, v239, 3, v246
    v_lshl_add_u32 v246, v238, 15, v246
    v_add_u32 v246, 28672, v246
    v_add_u32 v246, s78, v246
    v_xor_b32 v233, 16, v246
    v_xor_b32 v234, 32, v246
    v_xor_b32 v235, 48, v246
    v_bfe_u32 v236, v1, 2, 2
    v_lshl_add_u32 v236, v216, 2, v236
    v_lshlrev_b32 v236, 4, v236
    v_lshl_add_u32 v236, v203, 8, v236
    v_lshl_add_u32 v236, v238, 7, v236
    v_lshl_add_u32 v236, v239, 3, v236
    s_add_u32 s78, s78, 94208
    v_add_u32 v236, s78, v236
    v_xor_b32 v237, 16, v236
    v_xor_b32 v238, 32, v236
    v_xor_b32 v239, 48, v236
    v_xor_b32 v240, 64, v236
    v_xor_b32 v241, 80, v236
    v_xor_b32 v242, 96, v236
    v_xor_b32 v243, 112, v236
    s_waitcnt vmcnt(24)
    s_mov_b32 s3, 524288
L_ah_chk_7:
    v_xor_b32 v207, s74, v207
    v_cmp_lt_u32 vcc, 15, v207
    s_cbranch_vccnz L_ah_retry_8
L_ah_ok_9:
    s_barrier
    s_add_u32 s67, s86, s94
    s_add_u32 s78, s67, 4096
    s_add_u32 s79, s67, 16384
    s_add_u32 s80, s67, 20480
    s_mov_b32 s77, 524288
    buffer_load_dwordx4 v[212:215], v17, s[36:39], s67 offen sc1
    buffer_load_dwordx4 v[216:219], v17, s[36:39], s78 offen sc1
    buffer_load_dwordx4 v[220:223], v17, s[36:39], s79 offen sc1
    buffer_load_dwordx4 v[224:227], v17, s[36:39], s80 offen sc1
    s_waitcnt vmcnt(12)
    ds_read_b64_tr_b16 v[116:117], v246 offset:0
    ds_read_b64_tr_b16 v[118:119], v246 offset:256
    ds_read_b64_tr_b16 v[124:125], v233 offset:0
    ds_read_b64_tr_b16 v[126:127], v233 offset:256
    ds_read_b64_tr_b16 v[132:133], v234 offset:0
    ds_read_b64_tr_b16 v[134:135], v234 offset:256
    ds_read_b64_tr_b16 v[140:141], v235 offset:0
    ds_read_b64_tr_b16 v[142:143], v235 offset:256
    ds_read_b64_tr_b16 v[120:121], v246 offset:2048
    ds_read_b64_tr_b16 v[122:123], v246 offset:2304
    ds_read_b64_tr_b16 v[128:129], v233 offset:2048
    ds_read_b64_tr_b16 v[130:131], v233 offset:2304
    ds_read_b64_tr_b16 v[136:137], v234 offset:2048
    ds_read_b64_tr_b16 v[138:139], v234 offset:2304
    s_waitcnt lgkmcnt(12)
    ds_read_b64_tr_b16 v[144:145], v235 offset:2048
    ds_read_b64_tr_b16 v[146:147], v235 offset:2304
    s_waitcnt lgkmcnt(12)
    ds_read_b64_tr_b16 v[148:149], v246 offset:4096
    ds_read_b64_tr_b16 v[150:151], v246 offset:4352
    s_waitcnt lgkmcnt(12)
    ds_read_b64_tr_b16 v[156:157], v233 offset:4096
    ds_read_b64_tr_b16 v[158:159], v233 offset:4352
    s_waitcnt lgkmcnt(12)
    ds_read_b64_tr_b16 v[164:165], v234 offset:4096
    ds_read_b64_tr_b16 v[166:167], v234 offset:4352
    s_waitcnt lgkmcnt(12)
    ds_read_b64_tr_b16 v[172:173], v235 offset:4096
    ds_read_b64_tr_b16 v[174:175], v235 offset:4352
    s_waitcnt lgkmcnt(12)
    ds_read_b64_tr_b16 v[152:153], v246 offset:6144
    ds_read_b64_tr_b16 v[154:155], v246 offset:6400
    s_waitcnt lgkmcnt(12)
    ds_read_b64_tr_b16 v[160:161], v233 offset:6144
    ds_read_b64_tr_b16 v[162:163], v233 offset:6400
    s_waitcnt lgkmcnt(12)
    ds_read_b64_tr_b16 v[168:169], v234 offset:6144
    ds_read_b64_tr_b16 v[170:171], v234 offset:6400
    s_waitcnt lgkmcnt(12)
    ds_read_b64_tr_b16 v[176:177], v235 offset:6144
    ds_read_b64_tr_b16 v[178:179], v235 offset:6400
    s_waitcnt vmcnt(4)
    s_waitcnt lgkmcnt(12)
    ds_read_b64_tr_b16 v[180:181], v236 offset:0
    ds_read_b64_tr_b16 v[182:183], v236 offset:1024
    s_waitcnt lgkmcnt(12)
    ds_read_b64_tr_b16 v[184:185], v237 offset:0
    ds_read_b64_tr_b16 v[186:187], v237 offset:1024
    s_waitcnt lgkmcnt(12)
    ds_read_b64_tr_b16 v[188:189], v238 offset:0
    ds_read_b64_tr_b16 v[190:191], v238 offset:1024
    s_waitcnt lgkmcnt(12)
    ds_read_b64_tr_b16 v[192:193], v239 offset:0
    ds_read_b64_tr_b16 v[194:195], v239 offset:1024
    s_waitcnt lgkmcnt(12)
    ds_read_b64_tr_b16 v[196:197], v240 offset:0
    ds_read_b64_tr_b16 v[198:199], v240 offset:1024
    s_waitcnt lgkmcnt(12)
    ds_read_b64_tr_b16 v[200:201], v241 offset:0
    ds_read_b64_tr_b16 v[202:203], v241 offset:1024
    s_waitcnt lgkmcnt(12)
    ds_read_b64_tr_b16 v[204:205], v242 offset:0
    ds_read_b64_tr_b16 v[206:207], v242 offset:1024
    s_waitcnt lgkmcnt(12)
    ds_read_b64_tr_b16 v[208:209], v243 offset:0
    ds_read_b64_tr_b16 v[210:211], v243 offset:1024
    v_mov_b32 v240, 0
    v_mov_b32 v241, 0
    v_mov_b32 v242, 0
    v_mov_b32 v243, 0
    v_mov_b32 v244, 0
    v_mov_b32 v245, 0
    v_mov_b32 v246, 0
    v_mov_b32 v247, 0
    v_mov_b32 v248, 0
    v_mov_b32 v249, 0
    v_mov_b32 v250, 0
    v_mov_b32 v251, 0
    v_mov_b32 v252, 0
    v_mov_b32 v253, 0
    v_mov_b32 v254, 0
    v_mov_b32 v255, 0
    s_waitcnt lgkmcnt(0)
    s_branch L_b_swept
L_ex_notB:
    s_cmp_eq_u32 s81, 3
    s_cbranch_scc0 L_ex_notP
    s_barrier
    s_lshr_b32 s78, s60, 1
    s_sub_u32 s78, s78, 8
    s_lshl_b32 s79, s78, 6
    s_lshl_b32 s77, s72, 4
    s_add_u32 s79, s79, s77
    v_lshrrev_b32 v116, 2, v1
    v_add_u32 v116, s79, v116
    v_mul_u32_u24 v116, 2752, v116
    v_and_b32 v117, 3, v1
    v_lshlrev_b32 v117, 7, v117
    v_min_u32 v117, 0x17c, v117
    v_add_u32 v116, v116, v117
    buffer_load_dword v120, v116, s[48:51], 0 offen
    buffer_load_dword v121, v116, s[52:55], 0 offen
    s_mul_i32 s79, s78, 24576
    s_mul_i32 s77, s72, 6144
    s_add_u32 s79, s79, s77
    v_lshlrev_b32 v117, 7, v1
    v_cmp_gt_u32 vcc, 48, v1
    v_mov_b32 v247, 0x80000000
    s_nop 0
    v_cndmask_b32 v117, v247, v117, vcc
    buffer_load_dword v124, v117, s[56:59], s79 offen
L_ex_notP:
L_extras_done:
    s_cmp_eq_u32 s81, 1
    s_cbranch_scc0 L_notO
    buffer_load_dwordx4 v[212:215], v17, s[36:39], s85 offen sc1
    buffer_load_dwordx4 v[216:219], v18, s[36:39], s85 offen sc1
    s_cmp_eq_u32 s76, 0
    s_cbranch_scc1 L_o_frag
L_o_wait:
    s_mov_b32 s77, 524288
    s_branch L_o_poll_in
L_o_poll:
    buffer_load_dwordx4 v[212:215], v17, s[36:39], s85 offen sc1
    buffer_load_dwordx4 v[216:219], v18, s[36:39], s85 offen sc1
L_o_poll_in:
    s_sub_u32 s77, s77, 1
    s_cselect_b64 s[64:65], 0, -1
    s_waitcnt vmcnt(0)
    v_max3_u32 v242, v212, v213, v214
    v_max3_u32 v242, v242, v215, v216
    v_max3_u32 v242, v242, v217, v218
    v_max_u32 v242, v242, v219
    v_cmp_eq_u32 vcc, -1, v242
    s_and_b64 vcc, vcc, s[64:65]
    s_cbranch_scc1 L_o_poll
    v_mfma_f32_16x16x32_bf16 v[220:223], v[212:215], v[116:119], 0
    v_max_f32_dpp v236, v212, v212 quad_perm:[1,0,3,2] row_mask:0xf bank_mask:0xf
    v_mfma_f32_16x16x32_bf16 v[224:227], v[212:215], v[120:123], 0
    s_nop 0
    v_max_f32_dpp v236, v236, v236 quad_perm:[2,3,0,1] row_mask:0xf bank_mask:0xf
    v_mfma_f32_16x16x32_bf16 v[228:231], v[212:215], v[124:127], 0
    s_nop 0
    v_max_f32_dpp v236, v236, v236 row_half_mirror row_mask:0xf bank_mask:0xf
    v_mfma_f32_16x16x32_bf16 v[232:235], v[212:215], v[128:131], 0
    v_sub_f32 v237, v212, v236
    v_mfma_f32_16x16x32_bf16 v[220:223], v[216:219], v[132:135], v[220:223]
    v_exp_f32 v237, v237
    v_mfma_f32_16x16x32_bf16 v[224:227], v[216:219], v[136:139], v[224:227]
    s_nop 0
    v_mfma_f32_16x16x32_bf16 v[228:231], v[216:219], v[140:143], v[228:231]
    v_mul_f32 v236, v237, v213
    v_mfma_f32_16x16x32_bf16 v[232:235], v[216:219], v[144:147], v[232:235]
    s_nop 0
    v_add_f32_dpp v236, v236, v236 quad_perm:[1,0,3,2] row_mask:0xf bank_mask:0xf
    v_mul_f32_dpp v238, v237, v220 row_newbcast:8 row_mask:0xf bank_mask:0xf
    s_nop 0
    v_mul_f32_dpp v239, v237, v224 row_newbcast:8 row_mask:0xf bank_mask:0xf
    v_add_f32_dpp v236, v236, v236 quad_perm:[2,3,0,1] row_mask:0xf bank_mask:0xf
    v_mul_f32_dpp v240, v237, v228 row_newbcast:8 row_mask:0xf bank_mask:0xf
    s_nop 0
    v_mul_f32_dpp v241, v237, v232 row_newbcast:8 row_mask:0xf bank_mask:0xf
    v_fmac_f32_dpp v238, v237, v221 row_newbcast:9 row_mask:0xf bank_mask:0xf
    v_add_f32_dpp v236, v236, v236 row_half_mirror row_mask:0xf bank_mask:0xf
    v_fmac_f32_dpp v239, v237, v225 row_newbcast:9 row_mask:0xf bank_mask:0xf
    v_fmac_f32_dpp v240, v237, v229 row_newbcast:9 row_mask:0xf bank_mask:0xf
    v_fmac_f32_dpp v241, v237, v233 row_newbcast:9 row_mask:0xf bank_mask:0xf
    v_rcp_f32 v236, v236
    v_fmac_f32_dpp v238, v237, v222 row_newbcast:10 row_mask:0xf bank_mask:0xf
    v_fmac_f32_dpp v239, v237, v226 row_newbcast:10 row_mask:0xf bank_mask:0xf
    v_fmac_f32_dpp v240, v237, v230 row_newbcast:10 row_mask:0xf bank_mask:0xf
    v_fmac_f32_dpp v241, v237, v234 row_newbcast:10 row_mask:0xf bank_mask:0xf
    v_fmac_f32_dpp v238, v237, v223 row_newbcast:11 row_mask:0xf bank_mask:0xf
    v_fmac_f32_dpp v239, v237, v227 row_newbcast:11 row_mask:0xf bank_mask:0xf
    v_fmac_f32_dpp v240, v237, v231 row_newbcast:11 row_mask:0xf bank_mask:0xf
    v_fmac_f32_dpp v241, v237, v235 row_newbcast:11 row_mask:0xf bank_mask:0xf
    v_permlane16_swap_b32 v238, v239
    s_nop 0
    v_permlane16_swap_b32 v240, v241
    v_add_f32 v238, v238, v239
    v_add_f32 v240, v240, v241
    s_nop 1
    v_permlane32_swap_b32 v238, v240
    s_nop 1
    v_mul_f32_dpp v238, v236, v238 row_newbcast:8 row_mask:0xf bank_mask:0xf
    ds_write_b32 v19, v238
    s_cmp_lg_u32 s72, 0
    s_cbranch_scc1 L_o_other
    s_waitcnt vmcnt(0) lgkmcnt(0)
    s_barrier
    ds_read_b64 v[212:213], v20 offset:9088
    ds_read_b64 v[214:215], v20 offset:9344
    ds_read_b64 v[216:217], v20 offset:9600
    ds_read_b64 v[218:219], v20 offset:9856
    s_waitcnt lgkmcnt(2)
    v_pk_add_f32 v[212:213], v[212:213], v[214:215]
    s_waitcnt lgkmcnt(0)
    v_pk_add_f32 v[216:217], v[216:217], v[218:219]
    v_pk_add_f32 v[212:213], v[212:213], v[216:217]
    v_cvt_pk_bf16_f32 v212, v212, v213
    buffer_store_dword v212, v21, s[36:39], s86 offen sc1
    s_branch L_role_end
L_notO:
    s_cmp_eq_u32 s81, 2
    s_cbranch_scc0 L_role_end
    v_mov_b32 v240, 0
    v_mov_b32 v241, 0
    v_mov_b32 v242, 0
    v_mov_b32 v243, 0
    v_mov_b32 v244, 0
    v_mov_b32 v245, 0
    v_mov_b32 v246, 0
    v_mov_b32 v247, 0
    v_mov_b32 v248, 0
    v_mov_b32 v249, 0
    v_mov_b32 v250, 0
    v_mov_b32 v251, 0
    v_mov_b32 v252, 0
    v_mov_b32 v253, 0
    v_mov_b32 v254, 0
    v_mov_b32 v255, 0
    s_mov_b32 s77, 524288
L_b_res:
    buffer_load_dwordx4 v[228:231], v18, s[44:47], s89 offen sc1
    s_waitcnt vmcnt(0) lgkmcnt(0)
    v_max3_u32 v236, v228, v229, v230
    v_max_u32 v236, v236, v231
    v_cmp_eq_u32 vcc, -1, v236
    s_cbranch_vccnz L_retry_10
L_out_11:
    s_add_u32 s67, s86, s94
    s_add_u32 s78, s67, 4096
    s_add_u32 s79, s67, 16384
    s_add_u32 s80, s67, 20480
    s_mov_b32 s93, -1
L_b_light:
    s_mov_b32 s77, 524288
L_b_pre:
    buffer_load_dwordx4 v[212:215], v24, s[36:39], s67 offen sc1
    s_sub_u32 s77, s77, 1
    s_cselect_b64 s[64:65], 0, -1
    s_waitcnt vmcnt(0)
    v_max3_u32 v216, v212, v213, v214
    v_max_u32 v216, v216, v215
    v_cmp_eq_u32 vcc, -1, v216
    s_and_b64 vcc, vcc, s[64:65]
    s_cbranch_scc1 L_b_pre
    s_mov_b32 s77, 524288
L_b_poll:
    buffer_load_dwordx4 v[212:215], v17, s[36:39], s67 offen sc1
    buffer_load_dwordx4 v[216:219], v17, s[36:39], s78 offen sc1
    buffer_load_dwordx4 v[220:223], v17, s[36:39], s79 offen sc1
    buffer_load_dwordx4 v[224:227], v17, s[36:39], s80 offen sc1
L_b_swept:
    v_mfma_f32_16x16x32_bf16 v[232:235], v[32:35], v[228:231], 0
    s_waitcnt vmcnt(3)
    v_mfma_f32_16x16x32_bf16 v[232:235], v[32:35], v[212:215], v[232:235]
    v_max3_u32 v236, v212, v213, v214
    s_waitcnt vmcnt(2)
    v_mfma_f32_16x16x32_bf16 v[232:235], v[32:35], v[216:219], v[232:235]
    v_max3_u32 v236, v236, v215, v216
    v_max3_u32 v236, v236, v217, v218
    s_waitcnt vmcnt(1)
    v_mfma_f32_16x16x32_bf16 v[232:235], v[32:35], v[220:223], v[232:235]
    v_max3_u32 v236, v236, v219, v220
    v_max3_u32 v236, v236, v221, v222
    s_waitcnt vmcnt(0)
    v_mfma_f32_16x16x32_bf16 v[232:235], v[32:35], v[224:227], v[232:235]
    v_max3_u32 v236, v236, v223, v224
    v_max3_u32 v236, v236, v225, v226
    v_max_u32 v236, v236, v227
    v_cmp_eq_u32 vcc, -1, v236
L_b_check:
    s_nop 3
    v_cvt_pk_bf16_f32 v238, v232, v233
    v_cvt_pk_bf16_f32 v239, v234, v235
    s_cbranch_vccnz L_retry_12
L_out_13:
    ds_write2_b32 v19, v238, v239 offset1:32
    ds_read_b128 v[212:215], v20 offset:4864
    ds_read_b128 v[216:219], v20 offset:4928
    v_dot2_f32_bf16 v236, v238, s7, 0
    v_dot2_f32_bf16 v237, v238, v238, 0
    v_dot2_f32_bf16 v236, v239, s7, v236
    v_dot2_f32_bf16 v237, v239, v239, v237
    v_mov_b32 v228, 9024
    buffer_store_dwordx2 v[238:239], v23, s[36:39], s87 offen sc1
    v_add_f32_dpp v236, v236, v236 quad_perm:[1,0,3,2] row_mask:0xf bank_mask:0xf
    v_add_f32_dpp v237, v237, v237 quad_perm:[1,0,3,2] row_mask:0xf bank_mask:0xf
    s_nop 0
    v_add_f32_dpp v236, v236, v236 quad_perm:[2,3,0,1] row_mask:0xf bank_mask:0xf
    v_add_f32_dpp v237, v237, v237 quad_perm:[2,3,0,1] row_mask:0xf bank_mask:0xf
    s_nop 0
    v_add_f32_dpp v236, v236, v236 row_half_mirror row_mask:0xf bank_mask:0xf
    v_add_f32_dpp v237, v237, v237 row_half_mirror row_mask:0xf bank_mask:0xf
    s_nop 0
    v_add_f32_dpp v236, v236, v236 row_mirror row_mask:0xf bank_mask:0xf
    v_add_f32_dpp v237, v237, v237 row_mirror row_mask:0xf bank_mask:0xf
    s_waitcnt lgkmcnt(1)
    v_smfmac_f32_16x16x64_bf16 v[240:243], v[212:215], v[116:123], v27
    v_permlane16_swap_b32 v236, v237
    v_add_f32 v236, v236, v237
    v_smfmac_f32_16x16x64_bf16 v[244:247], v[212:215], v[124:131], v27
    v_mov_b32 v237, v236
    v_smfmac_f32_16x16x64_bf16 v[248:251], v[212:215], v[132:139], v27
    s_waitcnt lgkmcnt(0)
    v_permlane16_swap_b32 v236, v237
    ds_write_b64 v8, v[236:237]
    v_smfmac_f32_16x16x64_bf16 v[252:255], v[212:215], v[140:147], v27
    v_smfmac_f32_16x16x64_bf16 v[240:243], v[216:219], v[148:155], v27
    v_smfmac_f32_16x16x64_bf16 v[244:247], v[216:219], v[156:163], v27
    v_smfmac_f32_16x16x64_bf16 v[248:251], v[216:219], v[164:171], v27
    v_smfmac_f32_16x16x64_bf16 v[252:255], v[216:219], v[172:179], v27
    s_waitcnt lgkmcnt(0)
    s_barrier
    ds_read_b128 v[220:223], v228
    ds_read_b128 v[224:227], v228 offset:16
    s_nop 4
    v_pk_add_f32 v[240:241], v[240:241], v[242:243]
    ds_write_b64 v25, v[240:241] offset:6976
    v_pk_add_f32 v[244:245], v[244:245], v[246:247]
    ds_write_b64 v25, v[244:245] offset:7104
    v_pk_add_f32 v[248:249], v[248:249], v[250:251]
    ds_write_b64 v25, v[248:249] offset:7232
    v_pk_add_f32 v[252:253], v[252:253], v[254:255]
    ds_write_b64 v25, v[252:253] offset:7360
    s_waitcnt lgkmcnt(4)
    v_pk_add_f32 v[220:221], v[220:221], v[222:223]
    v_pk_add_f32 v[224:225], v[224:225], v[226:227]
    v_pk_add_f32 v[220:221], v[220:221], v[224:225]
    v_mul_f32 v230, 0x3b000000, v220
    v_mul_f32 v231, 0x3b000000, v221
    v_fma_f32 v231, -v230, v230, v231
    s_waitcnt lgkmcnt(0)
    s_barrier
    ds_read_b64 v[212:213], v3 offset:6976
    ds_read_b64 v[214:215], v3 offset:7488
    ds_read_b64 v[216:217], v3 offset:8000
    ds_read_b64 v[218:219], v3 offset:8512
    v_max_f32 v231, 0, v231
    v_add_f32 v231, 0x3727c5ac, v231
    v_rsq_f32 v231, v231
    s_waitcnt lgkmcnt(2)
    v_pk_add_f32 v[212:213], v[212:213], v[214:215]
    s_waitcnt lgkmcnt(0)
    v_pk_add_f32 v[216:217], v[216:217], v[218:219]
    v_pk_add_f32 v[212:213], v[212:213], v[216:217]
    v_fma_f32 v212, -v230, v213, v212
    v_mul_f32 v212, v212, v231
    v_mul_f32 v213, 0xbfb8aa3b, v212
    v_exp_f32 v213, v213
    v_mul_f32_dpp v214, v212, v212 row_ror:8 row_mask:0xf bank_mask:0xf
    v_add_f32 v213, 1.0, v213
    v_rcp_f32 v213, v213
    s_nop 0
    v_mul_f32 v213, v214, v213
    v_cvt_pk_bf16_f32 v213, v213, v213
    ds_write_b16 v21, v213
    ds_read_b128 v[212:215], v2 offset:3696
    ds_read_b128 v[216:219], v2 offset:3680
    ds_read_b128 v[220:223], v2 offset:3664
    ds_read_b128 v[224:227], v2 offset:3648
    ds_read_b128 v[228:231], v2 offset:3632
    ds_read_b128 v[232:235], v2 offset:3616
    ds_read_b128 v[236:239], v2 offset:3600
    ds_read_b128 v[240:243], v2 offset:3584
    s_waitcnt lgkmcnt(7)
    v_mfma_f32_16x16x32_bf16 v[244:247], v[180:183], v[212:215], 0
    s_waitcnt lgkmcnt(6)
    v_mfma_f32_16x16x32_bf16 v[244:247], v[184:187], v[216:219], v[244:247]
    s_waitcnt lgkmcnt(5)
    v_mfma_f32_16x16x32_bf16 v[244:247], v[188:191], v[220:223], v[244:247]
    s_waitcnt lgkmcnt(4)
    v_mfma_f32_16x16x32_bf16 v[244:247], v[192:195], v[224:227], v[244:247]
    s_waitcnt lgkmcnt(3)
    v_mfma_f32_16x16x32_bf16 v[244:247], v[196:199], v[228:231], v[244:247]
    s_waitcnt lgkmcnt(2)
    v_mfma_f32_16x16x32_bf16 v[244:247], v[200:203], v[232:235], v[244:247]
    s_waitcnt lgkmcnt(1)
    v_mfma_f32_16x16x32_bf16 v[244:247], v[204:207], v[236:239], v[244:247]
    s_waitcnt lgkmcnt(0)
    v_mfma_f32_16x16x32_bf16 v[244:247], v[208:211], v[240:243], v[244:247]
    s_nop 7
    v_cvt_pk_bf16_f32 v212, v244, v245
    v_cvt_pk_bf16_f32 v214, v244, v245
    v_cvt_pk_bf16_f32 v213, v246, v247
    v_cvt_pk_bf16_f32 v215, v246, v247
    v_permlane16_swap_b32 v212, v214
    s_nop 0
    v_permlane16_swap_b32 v213, v215
    buffer_store_dwordx4 v[212:215], v22, s[36:39], s87 offen sc1
L_role_end:
    s_cmp_eq_u32 s76, 0
    s_cbranch_scc1 L_x_go
    s_lshl_b32 s78, s90, 4
    s_or_b32 s78, s78, s72
    s_cmp_eq_u32 s78, 16
    s_cbranch_scc1 L_x_final
    s_branch L_finish
L_x_go:
    s_cmp_lg_u32 s72, 0
    s_cbranch_scc1 L_x_other
    s_cmp_eq_u32 s81, 2
    s_cbranch_scc1 L_x_cs_done
    v_lshlrev_b32 v236, 7, v1
    s_mov_b32 s78, 0x1000
    s_mov_b32 s77, 524288
L_ah:
    buffer_load_dword v212, v236, s[36:39], s78 offen sc1
    s_add_u32 s78, s78, 8192
    buffer_load_dword v213, v236, s[36:39], s78 offen sc1
    s_add_u32 s78, s78, 8192
    buffer_load_dword v214, v236, s[36:39], s78 offen sc1
    s_add_u32 s78, s78, 8192
    buffer_load_dword v215, v236, s[36:39], s78 offen sc1
    s_add_u32 s78, s78, 8192
    s_mov_b32 s78, 0x1000
    s_waitcnt vmcnt(0)
    v_xor_b32 v212, s74, v212
    v_bitop3_b32 v212, v213, s74, v212 bitop3:0xbe
    v_bitop3_b32 v212, v214, s74, v212 bitop3:0xbe
    v_bitop3_b32 v212, v215, s74, v212 bitop3:0xbe
    v_cmp_lt_u32 vcc, 15, v212
    s_cbranch_vccnz L_retry_14
L_out_15:
L_x_cs_done:
    s_cmp_eq_u32 s2, 255
    s_cbranch_scc1 L_ex_epoch
L_ex_epoch_done:
    s_xor_b32 s78, s68, 1
    s_mul_i32 s79, s78, 5
    s_min_u32 s78, s78, 3
    s_add_u32 s78, s78, s79
    s_lshl_b32 s78, s78, 7
    s_add_u32 s67, s94, s88
    s_add_u32 s3, s78, s67
    s_add_u32 s78, s67, 4096
    s_lshl_b32 s79, s70, 7
    s_mov_b32 s77, 524288
L_x_pre0:
    buffer_load_dwordx4 v[212:215], v16, s[36:39], s3 offen sc1
    s_sub_u32 s77, s77, 1
    s_cselect_b64 s[64:65], 0, -1
    s_waitcnt vmcnt(0)
    v_max3_u32 v216, v212, v213, v214
    v_max_u32 v216, v216, v215
    v_cmp_eq_u32 vcc, -1, v216
    s_and_b64 vcc, vcc, s[64:65]
    s_cbranch_scc1 L_x_pre0
    s_mov_b32 s77, 524288
L_x_poll0:
    buffer_load_dwordx4 v[212:215], v2, s[36:39], s67 offen offset:0 sc1
    buffer_load_dwordx4 v[216:219], v2, s[36:39], s67 offen offset:1024 sc1
    buffer_load_dwordx4 v[220:223], v2, s[36:39], s67 offen offset:2048 sc1
    buffer_load_dwordx4 v[224:227], v2, s[36:39], s67 offen offset:3072 sc1
    buffer_load_dwordx4 v[228:231], v2, s[36:39], s78 offen sc1
    buffer_load_dwordx4 v[232:235], v11, s[36:39], s78 offen offset:1024 sc1
    s_sub_u32 s77, s77, 1
    s_cselect_b64 s[64:65], 0, -1
    s_waitcnt vmcnt(5)
    v_mfma_f32_16x16x32_bf16 v[236:239], v[32:35], v[212:215], 0
    v_max3_u32 v242, v212, v213, v214
    s_waitcnt vmcnt(4)
    v_mfma_f32_16x16x32_bf16 v[236:239], v[32:35], v[216:219], v[236:239]
    v_max3_u32 v242, v242, v215, v216
    v_max3_u32 v242, v242, v217, v218
    s_waitcnt vmcnt(3)
    v_mfma_f32_16x16x32_bf16 v[236:239], v[32:35], v[220:223], v[236:239]
    v_max3_u32 v242, v242, v219, v220
    v_max3_u32 v242, v242, v221, v222
    s_waitcnt vmcnt(2)
    v_mfma_f32_16x16x32_bf16 v[236:239], v[32:35], v[224:227], v[236:239]
    v_max3_u32 v242, v242, v223, v224
    v_max3_u32 v242, v242, v225, v226
    s_waitcnt vmcnt(1)
    v_mfma_f32_16x16x32_bf16 v[236:239], v[32:35], v[228:231], v[236:239]
    v_max3_u32 v242, v242, v227, v228
    v_max3_u32 v242, v242, v229, v230
    s_waitcnt vmcnt(0)
    v_mfma_f32_16x16x32_bf16 v[236:239], v[32:35], v[232:235], v[236:239]
    v_max3_u32 v242, v242, v231, v232
    v_max3_u32 v242, v242, v233, v234
    v_max_u32 v242, v242, v235
    v_cmp_eq_u32 vcc, -1, v242
    s_and_b64 vcc, vcc, s[64:65]
    s_cbranch_scc1 L_x_poll0
    s_nop 1
    v_add_f32_dpp v236, v236, v236 row_ror:8 row_mask:0xf bank_mask:0xf
    v_add_f32_dpp v237, v237, v237 row_ror:8 row_mask:0xf bank_mask:0xf
    v_add_f32_dpp v238, v238, v238 row_ror:8 row_mask:0xf bank_mask:0xf
    v_add_f32_dpp v239, v239, v239 row_ror:8 row_mask:0xf bank_mask:0xf
    v_cvt_pk_bf16_f32 v240, v236, v237
    v_cvt_pk_bf16_f32 v241, v238, v239
    ds_write_b64 v4, v[240:241]
    v_dot2_f32_bf16 v232, v240, s7, 0
    v_dot2_f32_bf16 v233, v240, v240, 0
    v_dot2_f32_bf16 v232, v241, s7, v232
    v_dot2_f32_bf16 v233, v241, v241, v233
    s_add_u32 s78, s91, 0x4000
    s_lshl_b32 s79, s71, 7
    s_add_u32 s79, s79, s83
    s_add_u32 s79, s79, 0x8000
    s_add_u32 s80, s92, 0x4000
    s_mov_b32 s77, 524288
    s_waitcnt lgkmcnt(0)
    s_barrier
    ds_read_b128 v[212:215], v2 offset:16
    ds_read_b128 v[216:219], v2 offset:1040
    ds_read_b128 v[220:223], v2 offset:0
    ds_read_b128 v[224:227], v2 offset:1024
    ds_read_b64 v[242:243], v3 offset:4864
    v_add_f32_dpp v232, v232, v232 quad_perm:[1,0,3,2] row_mask:0xf bank_mask:0xf
    v_add_f32_dpp v233, v233, v233 quad_perm:[1,0,3,2] row_mask:0xf bank_mask:0xf
    s_nop 0
    v_add_f32_dpp v232, v232, v232 quad_perm:[2,3,0,1] row_mask:0xf bank_mask:0xf
    v_add_f32_dpp v233, v233, v233 quad_perm:[2,3,0,1] row_mask:0xf bank_mask:0xf
    s_nop 0
    v_add_f32_dpp v232, v232, v232 row_half_mirror row_mask:0xf bank_mask:0xf
    v_add_f32_dpp v233, v233, v233 row_half_mirror row_mask:0xf bank_mask:0xf
    s_nop 1
    v_permlane16_swap_b32 v232, v233
    v_add_f32 v232, v232, v233
    s_waitcnt lgkmcnt(4)
    v_mfma_f32_16x16x32_bf16 v[228:231], v[100:103], v[212:215], 0
    s_waitcnt lgkmcnt(3)
    v_mfma_f32_16x16x32_bf16 v[228:231], v[104:107], v[216:219], v[228:231]
    s_waitcnt lgkmcnt(2)
    v_mfma_f32_16x16x32_bf16 v[228:231], v[108:111], v[220:223], v[228:231]
    s_waitcnt lgkmcnt(1)
    v_mfma_f32_16x16x32_bf16 v[228:231], v[112:115], v[224:227], v[228:231]
    v_mov_b32 v233, v232
    s_cmp_eq_u32 s75, 0
    s_cbranch_scc1 L_q2_slow
    v_permlane16_swap_b32 v232, v233
    buffer_store_dwordx2 v[232:233], v15, s[36:39], s79 offen
    s_nop 2
    buffer_store_dwordx4 v[228:231], v5, s[36:39], s78 offen
L_q2_sent:
    s_nop 1
    buffer_load_dwordx2 v[228:229], v14, s[36:39], s79 offen sc1
    buffer_load_dwordx4 v[212:215], v2, s[36:39], s80 offen offset:0 sc1
    buffer_load_dwordx4 v[216:219], v2, s[36:39], s80 offen offset:1024 sc1
    buffer_load_dwordx4 v[220:223], v2, s[36:39], s80 offen offset:2048 sc1
    buffer_load_dwordx4 v[224:227], v2, s[36:39], s80 offen offset:3072 sc1
    s_mov_b32 s76, 1
    s_add_u32 s84, s84, 8704
    s_add_u32 s85, s85, 8704
    s_add_u32 s86, s86, 180224
    s_add_u32 s87, s87, 180224
    s_add_u32 s88, s88, 180224
    s_mov_b32 s44, s36
    s_mov_b32 s45, s37
    s_mov_b32 s46, s38
    s_mov_b32 s47, s39
    s_add_u32 s89, s86, 32768
    s_waitcnt lgkmcnt(0)
    s_branch L_pq2_in
L_pq2:
    buffer_load_dwordx2 v[228:229], v14, s[36:39], s79 offen sc1
    buffer_load_dwordx4 v[212:215], v2, s[36:39], s80 offen offset:0 sc1
    buffer_load_dwordx4 v[216:219], v2, s[36:39], s80 offen offset:1024 sc1
    buffer_load_dwordx4 v[220:223], v2, s[36:39], s80 offen offset:2048 sc1
    buffer_load_dwordx4 v[224:227], v2, s[36:39], s80 offen offset:3072 sc1
L_pq2_in:
    s_sub_u32 s77, s77, 1
    s_cselect_b64 s[64:65], 0, -1
    s_waitcnt vmcnt(4)
    v_add_f32_dpp v230, v228, v228 quad_perm:[1,0,3,2] row_mask:0xf bank_mask:0xf
    v_add_f32_dpp v231, v229, v229 quad_perm:[1,0,3,2] row_mask:0xf bank_mask:0xf
    s_waitcnt vmcnt(2)
    v_max3_u32 v236, v228, v229, v212
    v_add_f32_dpp v230, v230, v230 quad_perm:[2,3,0,1] row_mask:0xf bank_mask:0xf
    v_add_f32_dpp v231, v231, v231 quad_perm:[2,3,0,1] row_mask:0xf bank_mask:0xf
    v_max3_u32 v236, v236, v213, v214
    v_add_f32_dpp v230, v230, v230 row_half_mirror row_mask:0xf bank_mask:0xf
    v_add_f32_dpp v231, v231, v231 row_half_mirror row_mask:0xf bank_mask:0xf
    v_max3_u32 v236, v236, v215, v216
    v_max3_u32 v236, v236, v217, v218
    v_pk_add_f32 v[238:239], v[212:213], v[216:217]
    v_pk_add_f32 v[240:241], v[214:215], v[218:219]
    v_mul_f32 v232, 0x3b000000, v230
    v_mul_f32 v233, 0x3b000000, v231
    v_fma_f32 v233, -v232, v232, v233
    s_waitcnt vmcnt(0)
    v_max3_u32 v236, v236, v219, v220
    v_max3_u32 v236, v236, v221, v222
    v_max3_u32 v236, v236, v223, v224
    v_max3_u32 v236, v236, v225, v226
    v_max_u32 v236, v236, v227
    v_cmp_eq_u32 vcc, -1, v236
    v_pk_add_f32 v[238:239], v[238:239], v[220:221]
    v_max_f32 v233, 0, v233
    v_pk_add_f32 v[240:241], v[240:241], v[222:223]
    v_add_f32 v233, 0x3727c5ac, v233
    v_pk_add_f32 v[238:239], v[238:239], v[224:225]
    v_rsq_f32 v233, v233
    v_pk_add_f32 v[240:241], v[240:241], v[226:227]
    s_and_b64 vcc, vcc, s[64:65]
    s_cbranch_scc1 L_pq2
    v_permlane32_swap_b32 v238, v239
    v_permlane32_swap_b32 v240, v241
    v_add_f32 v238, v238, v239
    v_add_f32 v240, v240, v241
    v_fma_f32 v238, -v232, v242, v238
    v_fma_f32 v240, -v232, v243, v240
    v_mul_f32 v238, v238, v233
    v_mul_f32 v240, v240, v233
    v_cvt_pk_bf16_f32 v238, v238, v240
    ds_write_b16 v6, v238
    ds_write_b16_d16_hi v6, v238 offset:4
    s_branch L_layer_bar
L_x_done:
    s_add_u32 s78, s91, 0x4000
    s_lshl_b32 s79, s71, 7
    s_add_u32 s79, s79, s83
    s_add_u32 s79, s79, 0x8000
    s_barrier
    ds_read_b128 v[212:215], v2 offset:16
    ds_read_b128 v[216:219], v2 offset:1040
    ds_read_b128 v[220:223], v2 offset:0
    ds_read_b128 v[224:227], v2 offset:1024
    s_waitcnt lgkmcnt(3)
    v_mfma_f32_16x16x32_bf16 v[228:231], v[100:103], v[212:215], 0
    s_waitcnt lgkmcnt(2)
    v_mfma_f32_16x16x32_bf16 v[228:231], v[104:107], v[216:219], v[228:231]
    s_waitcnt lgkmcnt(1)
    v_mfma_f32_16x16x32_bf16 v[228:231], v[108:111], v[220:223], v[228:231]
    s_waitcnt lgkmcnt(0)
    v_mfma_f32_16x16x32_bf16 v[228:231], v[112:115], v[224:227], v[228:231]
    s_cmp_eq_u32 s75, 0
    s_cbranch_scc1 L_slow_18
    s_nop 5
    buffer_store_dwordx4 v[228:231], v5, s[36:39], s78 offen
L_done_19:
    s_mov_b32 s76, 1
    s_add_u32 s84, s84, 8704
    s_add_u32 s85, s85, 8704
    s_add_u32 s86, s86, 180224
    s_add_u32 s87, s87, 180224
    s_add_u32 s88, s88, 180224
    s_mov_b32 s44, s36
    s_mov_b32 s45, s37
    s_mov_b32 s46, s38
    s_mov_b32 s47, s39
    s_add_u32 s89, s86, 32768
    s_lshl_b32 s78, s90, 4
    s_or_b32 s78, s78, s72
    s_cmp_eq_u32 s78, 17
    s_cbranch_scc0 L_layer_bar
    ds_read_b64 v[236:237], v4
    s_lshl_b32 s78, s70, 7
    s_add_u32 s78, s78, s89
    s_waitcnt lgkmcnt(0)
    buffer_store_dwordx2 v[236:237], v12, s[36:39], s78 offen sc1
    s_branch L_layer_bar
L_x_final:
    s_xor_b32 s78, s68, 1
    s_mul_i32 s79, s78, 5
    s_min_u32 s78, s78, 3
    s_add_u32 s78, s78, s79
    s_lshl_b32 s78, s78, 7
    s_add_u32 s67, s94, s88
    s_add_u32 s3, s78, s67
    s_add_u32 s78, s67, 4096
    s_lshl_b32 s79, s70, 7
    s_mov_b32 s77, 524288
L_x_pre1:
    buffer_load_dwordx4 v[212:215], v16, s[36:39], s3 offen sc1
    s_sub_u32 s77, s77, 1
    s_cselect_b64 s[64:65], 0, -1
    s_waitcnt vmcnt(0)
    v_max3_u32 v216, v212, v213, v214
    v_max_u32 v216, v216, v215
    v_cmp_eq_u32 vcc, -1, v216
    s_and_b64 vcc, vcc, s[64:65]
    s_cbranch_scc1 L_x_pre1
    s_mov_b32 s77, 524288
L_x_poll1:
    buffer_load_dwordx4 v[212:215], v2, s[36:39], s67 offen offset:0 sc1
    buffer_load_dwordx4 v[216:219], v2, s[36:39], s67 offen offset:1024 sc1
    buffer_load_dwordx4 v[220:223], v2, s[36:39], s67 offen offset:2048 sc1
    buffer_load_dwordx4 v[224:227], v2, s[36:39], s67 offen offset:3072 sc1
    buffer_load_dwordx4 v[228:231], v2, s[36:39], s78 offen sc1
    buffer_load_dwordx4 v[232:235], v11, s[36:39], s78 offen offset:1024 sc1
    s_sub_u32 s77, s77, 1
    s_cselect_b64 s[64:65], 0, -1
    s_waitcnt vmcnt(5)
    v_mfma_f32_16x16x32_bf16 v[236:239], v[32:35], v[212:215], 0
    v_max3_u32 v242, v212, v213, v214
    s_waitcnt vmcnt(4)
    v_mfma_f32_16x16x32_bf16 v[236:239], v[32:35], v[216:219], v[236:239]
    v_max3_u32 v242, v242, v215, v216
    v_max3_u32 v242, v242, v217, v218
    s_waitcnt vmcnt(3)
    v_mfma_f32_16x16x32_bf16 v[236:239], v[32:35], v[220:223], v[236:239]
    v_max3_u32 v242, v242, v219, v220
    v_max3_u32 v242, v242, v221, v222
    s_waitcnt vmcnt(2)
    v_mfma_f32_16x16x32_bf16 v[236:239], v[32:35], v[224:227], v[236:239]
    v_max3_u32 v242, v242, v223, v224
    v_max3_u32 v242, v242, v225, v226
    s_waitcnt vmcnt(1)
    v_mfma_f32_16x16x32_bf16 v[236:239], v[32:35], v[228:231], v[236:239]
    v_max3_u32 v242, v242, v227, v228
    v_max3_u32 v242, v242, v229, v230
    s_waitcnt vmcnt(0)
    v_mfma_f32_16x16x32_bf16 v[236:239], v[32:35], v[232:235], v[236:239]
    v_max3_u32 v242, v242, v231, v232
    v_max3_u32 v242, v242, v233, v234
    v_max_u32 v242, v242, v235
    v_cmp_eq_u32 vcc, -1, v242
    s_and_b64 vcc, vcc, s[64:65]
    s_cbranch_scc1 L_x_poll1
    s_nop 1
    v_add_f32_dpp v236, v236, v236 row_ror:8 row_mask:0xf bank_mask:0xf
    v_add_f32_dpp v237, v237, v237 row_ror:8 row_mask:0xf bank_mask:0xf
    v_add_f32_dpp v238, v238, v238 row_ror:8 row_mask:0xf bank_mask:0xf
    v_add_f32_dpp v239, v239, v239 row_ror:8 row_mask:0xf bank_mask:0xf
    v_cvt_pk_bf16_f32 v240, v236, v237
    v_cvt_pk_bf16_f32 v241, v238, v239
    buffer_store_dwordx2 v[240:241], v12, s[40:43], s79 offen
L_finish:
L_end:
    s_endpgm
L_helper:
    s_mov_b32 s36, s26
    s_and_b32 s37, s27, 0xffff
    s_lshl_b32 s10, s68, 14
    s_lshl_b32 s78, s69, 7
    s_add_u32 s10, s10, s78
    s_add_u32 s10, s10, 0x124000
    s_and_b32 s77, s69, 1
    s_lshl_b32 s78, s77, 13
    s_add_u32 s10, s10, s78
    s_xor_b32 s11, s10, 8192
    ds_write_b128 v2, v[220:223] offset:2304
    ds_write_b128 v2, v[220:223] offset:3328
    ds_write_b128 v2, v[220:223] offset:4352
    ds_write_b128 v2, v[224:227] offset:5952
    buffer_load_dword v118, off, s[36:39], 0 offset:0 sc1
    s_lshl_b32 s93, s69, 11
    s_add_u32 s93, s93, s83
    buffer_store_dwordx4 v[212:215], v2, s[36:39], s93 offen sc1
    buffer_store_dwordx4 v[212:215], v2, s[36:39], s93 offen offset:1024 sc1
    v_and_b32 v236, 0x70, v2
    v_lshrrev_b32 v237, 3, v1
    s_lshr_b32 s78, s69, 1
    s_bitcmp1_b32 s69, 0
    s_cbranch_scc1 L_h_odd
    s_lshr_b32 s79, s78, 3
    s_lshl_b32 s80, s68, 1
    s_add_u32 s79, s79, s80
    s_and_b32 s80, s79, 8
    s_add_u32 s79, s79, s80
    s_lshl_b32 s79, s79, 10
    s_and_b32 s78, s78, 7
    s_lshl_b32 s78, s78, 7
    s_add_u32 s78, s78, s79
    s_add_u32 s78, s78, 0xac000
    v_mul_u32_u24 v238, 180224, v241
    v_and_b32 v237, 1, v237
    v_lshl_add_u32 v238, v237, 13, v238
    v_add_u32 v238, v238, v236
    v_cmp_gt_u32 vcc, 32, v1
    v_mov_b32 v247, 0x80000000
    s_nop 0
    v_cndmask_b32 v238, v247, v238, vcc
    buffer_store_dwordx4 v[212:215], v238, s[36:39], s78 offen sc1
    s_branch L_h_fin
L_h_odd:
    s_cmp_lt_u32 s68, 3
    s_cselect_b32 s80, 6, 5
    s_cmp_lt_u32 s78, s80
    s_cbranch_scc0 L_h_fin
    s_mul_i32 s79, s68, 5
    s_min_u32 s80, s68, 3
    s_add_u32 s79, s79, s80
    s_add_u32 s79, s79, s78
    s_lshl_b32 s78, s79, 7
    s_add_u32 s78, s78, 0xb8000
    v_mul_u32_u24 v238, 16384, v237
    v_add_u32 v238, v238, v236
    buffer_store_dwordx4 v[212:215], v238, s[36:39], s78 offen sc1
    s_add_u32 s78, s78, 8192
    buffer_store_dwordx4 v[212:215], v238, s[36:39], s78 offen sc1
    s_add_u32 s78, s78, 172032
    buffer_store_dwordx4 v[212:215], v238, s[36:39], s78 offen sc1
    s_add_u32 s78, s78, 8192
    buffer_store_dwordx4 v[212:215], v238, s[36:39], s78 offen sc1
    s_cmp_eq_u32 s79, 0
    s_cbranch_scc0 L_h_fin
    s_mov_b32 s78, 0xb9580
    buffer_store_dwordx4 v[212:215], v238, s[36:39], s78 offen sc1
    s_add_u32 s78, s78, 8192
    buffer_store_dwordx4 v[212:215], v238, s[36:39], s78 offen sc1
    s_add_u32 s78, s78, 172032
    buffer_store_dwordx4 v[212:215], v238, s[36:39], s78 offen sc1
    s_add_u32 s78, s78, 8192
    buffer_store_dwordx4 v[212:215], v238, s[36:39], s78 offen sc1
L_h_fin:
    s_lshl_b32 s78, s68, 3
    s_add_u32 s78, s78, s68
    s_add_u32 s78, s78, 192
    s_cmp_eq_u32 s78, s2
    s_cbranch_scc0 L_h_cleared
    s_lshl_b32 s78, s70, 7
    s_add_u32 s78, s78, 0xe0000
    v_cmp_gt_u32 vcc, 8, v1
    v_mov_b32 v247, 0x80000000
    s_nop 0
    v_cndmask_b32 v238, v247, v2, vcc
    buffer_store_dwordx4 v[212:215], v238, s[36:39], s78 offen sc1
L_h_cleared:
    s_waitcnt lgkmcnt(0)
    s_load_dword s8, s[26:27], s10
    s_load_dword s9, s[26:27], s11
    s_mov_b32 s79, 40
L_race:
    s_getreg_b32 s75, hwreg(HW_REG_IB_STS, 8, 4)
    s_sub_u32 s79, s79, 1
    s_cselect_b32 s75, 0, s75
    s_cmp_ge_u32 s75, 2
    s_cbranch_scc1 L_race
    s_lshl_b32 s77, s77, 1
    s_sub_u32 s77, s77, 1
    s_mul_i32 s75, s75, s77
    s_barrier
    s_mov_b32 s40, s22
    s_and_b32 s41, s23, 0xffff
    v_mov_b32 v237, 0
    v_cmp_eq_u32 vcc, 0, v1
    v_mov_b32 v247, 0x80000000
    s_nop 0
    v_cndmask_b32 v13, v247, v237, vcc
    s_lshl_b32 s78, s68, 5
    s_add_u32 s78, s78, s69
    s_lshl_b32 s78, s78, 7
    s_add_u32 s78, s78, 0x1000
    v_cmp_gt_u32 vcc, 8, v1
    v_mov_b32 v247, 0x80000000
    s_nop 0
    v_cndmask_b32 v239, v247, v2, vcc
    v_lshlrev_b32 v237, 6, v1
    v_cmp_gt_u32 vcc, 32, v1
    v_mov_b32 v247, 0x80000000
    s_nop 0
    v_cndmask_b32 v237, v247, v237, vcc
    s_waitcnt vmcnt(0)
    v_readfirstlane_b32 s73, v118
    s_getreg_b32 s79, hwreg(HW_REG_XCC_ID, 0, 4)
    s_mul_i32 s73, s73, 0x9e3779b1
    s_add_u32 s73, s73, 0x7f4a7c15
    s_and_b32 s74, s73, 0xfffffff0
    s_or_b32 s74, s74, s79
    v_mov_b32 v216, s74
    v_mov_b32 v217, s75
    v_mov_b32 v218, s74
    v_mov_b32 v219, s74
    buffer_store_dwordx4 v[216:219], v239, s[36:39], s78 offen sc1
    buffer_load_dword v116, v237, s[36:39], s93 offen sc1
    buffer_load_dword v117, v13, s[40:43], 0 offen
L_helper_end:
    s_endpgm
L_pq1_retry:
    s_cmp_lg_u32 s78, 1
    s_cbranch_scc1 L_pq1_n1
    s_mov_b32 s78, 2
    s_waitcnt vmcnt(8)
    v_mov_b32 v212, v116
    v_mov_b32 v213, v117
    v_mov_b32 v214, v118
    v_mov_b32 v215, v119
    v_mov_b32 v216, v120
    v_mov_b32 v217, v121
    v_mov_b32 v218, v122
    v_mov_b32 v219, v123
    v_mov_b32 v220, v124
    v_mov_b32 v221, v125
    v_mov_b32 v222, v126
    v_mov_b32 v223, v127
    v_mov_b32 v224, v128
    v_mov_b32 v225, v129
    v_mov_b32 v226, v130
    v_mov_b32 v227, v131
    s_branch L_pq1_chk
L_pq1_n1:
    s_cmp_lg_u32 s78, 2
    s_cbranch_scc1 L_pq1_n2
    s_mov_b32 s78, 3
    s_waitcnt vmcnt(1)
    v_mov_b32 v212, v132
    v_mov_b32 v213, v133
    v_mov_b32 v214, v134
    v_mov_b32 v215, v135
    v_mov_b32 v216, v136
    v_mov_b32 v217, v137
    v_mov_b32 v218, v138
    v_mov_b32 v219, v139
    v_mov_b32 v220, v140
    v_mov_b32 v221, v141
    v_mov_b32 v222, v142
    v_mov_b32 v223, v143
    v_mov_b32 v224, v144
    v_mov_b32 v225, v145
    v_mov_b32 v226, v146
    v_mov_b32 v227, v147
    s_branch L_pq1_chk
L_pq1_n2:
    s_lshl_b32 s78, s66, 3
    s_add_u32 s78, s78, s70
    s_lshl_b32 s78, s78, 9
    s_add_u32 s78, s78, 0x9000
    buffer_load_dwordx4 v[196:199], v11, s[36:39], s78 offen sc1
    s_waitcnt vmcnt(0)
    v_xor_b32 v228, s73, v197
    v_bitop3_b32 v228, v199, s73, v228 bitop3:0xbe
    v_cmp_eq_u32 vcc, 0, v228
    v_mov_b32 v247, 0x80000000
    s_nop 0
    v_cndmask_b32 v228, v247, v11, vcc
    buffer_store_dwordx4 v[196:199], v228, s[36:39], s78 offen sc1
    s_mov_b32 s78, 3
    buffer_load_dwordx4 v[212:215], v2, s[36:39], s79 offen offset:0 sc1
    buffer_load_dwordx4 v[216:219], v2, s[36:39], s79 offen offset:1024 sc1
    buffer_load_dwordx4 v[220:223], v2, s[36:39], s79 offen offset:2048 sc1
    buffer_load_dwordx4 v[224:227], v2, s[36:39], s79 offen offset:3072 sc1
    s_waitcnt vmcnt(0)
    s_sub_u32 s77, s77, 1
    s_cbranch_scc0 L_pq1_chk
    s_branch L_pq1_ok
L_hello_retry:
    buffer_load_dwordx2 v[200:201], v205, s[36:39], 0 offen sc1
    s_waitcnt vmcnt(0)
    s_sub_u32 s77, s77, 1
    s_cbranch_scc0 L_hello_chk
    s_branch L_hello_ok
L_slow_1:
    buffer_store_dword v232, v9, s[36:39], s84 offen sc1
    s_branch L_done_2
L_slow_3:
    buffer_store_dwordx4 v[228:231], v10, s[36:39], s84 offen sc1
    s_branch L_done_4
L_p1_not0:
    s_cmp_lg_u32 s72, 1
    s_cbranch_scc1 L_p1_idle
    v_mov_b32 v230, 0
    v_mov_b32 v231, 0
    s_waitcnt lgkmcnt(0)
    s_barrier
    ds_read_b128 v[212:215], v228
    ds_read_b128 v[216:219], v228 offset:16
    ds_read_b32 v229, v228 offset:32
    s_waitcnt lgkmcnt(0)
    v_max3_f32 v228, v212, v214, v216
    v_readfirstlane_b32 s94, v229
    v_max_f32 v228, v228, v218
    v_sub_f32 v212, v212, v228
    v_sub_f32 v214, v214, v228
    v_sub_f32 v216, v216, v228
    v_sub_f32 v218, v218, v228
    v_exp_f32 v212, v212
    v_exp_f32 v214, v214
    v_exp_f32 v216, v216
    v_exp_f32 v218, v218
    s_and_b32 s75, s94, 1
    v_mul_f32 v229, v212, v213
    v_fmac_f32 v229, v214, v215
    v_fmac_f32 v229, v216, v217
    v_fmac_f32 v229, v218, v219
    s_cbranch_scc0 L_slow_3
    buffer_store_dwordx4 v[228:231], v10, s[36:39], s84 offen
L_done_4:
    s_branch L_p1_done
L_p1_idle:
    s_waitcnt lgkmcnt(0)
    s_barrier
    ds_read_b32 v229, v228 offset:32
    s_waitcnt lgkmcnt(0)
    v_readfirstlane_b32 s94, v229
    s_and_b32 s75, s94, 1
    s_branch L_p1_done
L_slow_5:
    buffer_store_dwordx4 v[208:211], v202, s[36:39], s91 offen sc1
    s_branch L_done_6
L_ex_through:
    s_lshl_b32 s78, s66, 3
    s_add_u32 s78, s78, s70
    s_lshl_b32 s78, s78, 9
    s_add_u32 s78, s78, 0x9000
    buffer_load_dwordx4 v[216:219], v11, s[36:39], s78 offen sc1
    s_waitcnt vmcnt(0)
    v_xor_b32 v220, s73, v217
    v_bitop3_b32 v220, v219, s73, v220 bitop3:0xbe
    v_cmp_eq_u32 vcc, 0, v220
    v_mov_b32 v247, 0x80000000
    s_nop 0
    v_cndmask_b32 v220, v247, v11, vcc
    buffer_store_dwordx4 v[216:219], v220, s[36:39], s78 offen sc1
    s_branch L_ex_through_done
L_ah_retry_8:
    buffer_load_dword v207, v206, s[36:39], 0 offen sc1
    s_waitcnt vmcnt(0)
    s_sub_u32 s3, s3, 1
    s_cbranch_scc0 L_ah_chk_7
    s_branch L_ah_ok_9
L_o_frag:
    v_xor_b32 v221, 32, v22
    v_xor_b32 v222, 64, v22
    v_xor_b32 v223, 96, v22
    s_waitcnt vmcnt(2)
    ds_read_b64_tr_b16 v[116:117], v22 offset:0
    ds_read_b64_tr_b16 v[118:119], v22 offset:512
    ds_read_b64_tr_b16 v[120:121], v221 offset:0
    ds_read_b64_tr_b16 v[122:123], v221 offset:512
    ds_read_b64_tr_b16 v[124:125], v222 offset:0
    ds_read_b64_tr_b16 v[126:127], v222 offset:512
    ds_read_b64_tr_b16 v[128:129], v223 offset:0
    ds_read_b64_tr_b16 v[130:131], v223 offset:512
    ds_read_b64_tr_b16 v[132:133], v22 offset:4096
    ds_read_b64_tr_b16 v[134:135], v22 offset:4608
    ds_read_b64_tr_b16 v[136:137], v221 offset:4096
    ds_read_b64_tr_b16 v[138:139], v221 offset:4608
    s_waitcnt lgkmcnt(8)
    ds_read_b64_tr_b16 v[140:141], v222 offset:4096
    ds_read_b64_tr_b16 v[142:143], v222 offset:4608
    ds_read_b64_tr_b16 v[144:145], v223 offset:4096
    ds_read_b64_tr_b16 v[146:147], v223 offset:4608
    s_waitcnt lgkmcnt(0)
    s_branch L_o_wait
L_o_other:
    s_waitcnt vmcnt(0) lgkmcnt(0)
    s_barrier
    s_branch L_role_end
L_retry_10:
    s_sub_u32 s77, s77, 1
    s_cbranch_scc0 L_b_res
    s_branch L_out_11
L_retry_12:
    s_sub_u32 s77, s77, 1
    s_cbranch_scc0 L_b_poll
    s_branch L_out_13
L_retry_14:
    s_sub_u32 s77, s77, 1
    s_cbranch_scc0 L_ah
    s_branch L_out_15
L_retry_16:
    s_sub_u32 s77, s77, 1
    s_cbranch_scc0 L_cs
    s_branch L_out_17
L_x_other:
    s_cmp_lg_u32 s72, 1
    s_cbranch_scc1 L_x_done
    s_mov_b32 s77, 524288
L_cs:
    buffer_load_dwordx4 v[212:215], v2, s[36:39], s92 offen offset:0 sc1
    buffer_load_dwordx4 v[216:219], v2, s[36:39], s92 offen offset:1024 sc1
    buffer_load_dwordx4 v[220:223], v2, s[36:39], s92 offen offset:2048 sc1
    buffer_load_dwordx4 v[224:227], v2, s[36:39], s92 offen offset:3072 sc1
    s_waitcnt vmcnt(0)
    v_max3_u32 v236, v212, v213, v214
    v_max3_u32 v236, v236, v215, v216
    v_max3_u32 v236, v236, v217, v218
    v_max3_u32 v236, v236, v219, v220
    v_max3_u32 v236, v236, v221, v222
    v_max3_u32 v236, v236, v223, v224
    v_max3_u32 v236, v236, v225, v226
    v_max_u32 v236, v236, v227
    v_cmp_eq_u32 vcc, -1, v236
    s_cbranch_vccnz L_retry_16
L_out_17:
    v_pk_add_f32 v[212:213], v[212:213], v[216:217]
    v_pk_add_f32 v[214:215], v[214:215], v[218:219]
    v_pk_add_f32 v[220:221], v[220:221], v[224:225]
    v_pk_add_f32 v[222:223], v[222:223], v[226:227]
    v_pk_add_f32 v[212:213], v[212:213], v[220:221]
    v_pk_add_f32 v[214:215], v[214:215], v[222:223]
    s_nop 0
    v_permlane32_swap_b32 v212, v213
    v_permlane32_swap_b32 v214, v215
    v_add_f32 v212, v212, v213
    v_add_f32 v214, v214, v215
    v_mov_b32 v213, v214
    ds_write_b64 v3, v[212:213] offset:4864
    s_waitcnt lgkmcnt(0)
    s_branch L_x_done
L_ex_epoch:
    v_mov_b32 v216, s73
    buffer_store_dword v216, v13, s[36:39], 0 offen offset:0 sc1
    s_branch L_ex_epoch_done
L_q2_slow:
    v_permlane16_swap_b32 v232, v233
    buffer_store_dwordx2 v[232:233], v15, s[36:39], s79 offen sc1
    s_nop 2
    buffer_store_dwordx4 v[228:231], v5, s[36:39], s78 offen sc1
    s_branch L_q2_sent
L_slow_18:
    s_nop 5
    buffer_store_dwordx4 v[228:231], v5, s[36:39], s78 offen sc1
    s_branch L_done_19
L_code_end:
.section .rodata,"a"
.p2align 6
.amdhsa_kernel interleave_layers__sliding_block_cached__glu_gated_swiglu__decode_kernel
  .amdhsa_next_free_vgpr 256
  .amdhsa_next_free_sgpr 102
  .amdhsa_accum_offset 256
  .amdhsa_group_segment_fixed_size 0
  .amdhsa_kernarg_size 96
  .amdhsa_user_sgpr_count 2
  .amdhsa_user_sgpr_kernarg_segment_ptr 1
  .amdhsa_system_sgpr_workgroup_id_x 1
  .amdhsa_float_denorm_mode_32 3
.end_amdhsa_kernel
```
